```python
import torch

def _softmax(x, axis=-1):
    return torch.softmax(x, dim=axis)
def _gelu(x):
    return torch.nn.functional.gelu(x, approximate="tanh")
def _silu(x):
    return torch.nn.functional.silu(x)
def _sigmoid(x):
    return torch.sigmoid(x)
def _layernorm(x, axis=-1, eps=1e-5):
    m = x.mean(dim=axis, keepdim=True)
    v = x.var(dim=axis, keepdim=True, unbiased=False)
    return (x - m) / torch.sqrt(v + eps)
def _scatter_add(tgt, idx, src, axis=0):
    return tgt.clone().index_add_(axis, idx, src)
def _segment_sum(src, seg, n):
    out = torch.zeros((n,) + src.shape[1:], dtype=src.dtype)
    return out.index_add_(0, seg, src)
def _pad(x, pw):
    flat = tuple(v for pair in reversed(pw) for v in pair)
    return torch.nn.functional.pad(x, flat)

kernel_name = 'standalone__gqa_softmax__near_ridge'

def setup_inputs():

    _w = (lambda a: (lambda t: t.to(torch.bfloat16) if t.is_floating_point() else t)(torch.as_tensor(a)))
    B, Hq, Hkv, Sq, Sk, D = 16, 32, 8, 64, 512, 128
    return {
        "q": _w((lambda *s: torch.randn(*s, dtype=torch.bfloat16) * 0.8)(B, Hq, Sq, D)),
        "k": _w((lambda *s: torch.randn(*s, dtype=torch.bfloat16) * 0.8)(B, Hkv, Sk, D)),
        "v": _w((lambda *s: torch.randn(*s, dtype=torch.bfloat16) * 0.05)(B, Hkv, Sk, D)),
    }

def reference(q, k, v):
    B, Hq, Sq, D = q.shape
    Hkv = k.shape[1]
    rep = Hq // Hkv
    k = (lambda x, n, axis: torch.repeat_interleave(x, n, dim=axis))(k, rep, axis=1)
    v = (lambda x, n, axis: torch.repeat_interleave(x, n, dim=axis))(v, rep, axis=1)
    scale = D ** -0.5
    scores = torch.einsum("bhqd,bhkd->bhqk", q, k) * scale
    p = _softmax(scores, axis=-1)
    return torch.einsum("bhqk,bhkd->bhqd", p, v)
```

```asm
; @launch grid=(256,1,1) block=(256,1,1) lds=163840
.amdgcn_target "amdgcn-amd-amdhsa--gfx950"
.text
.globl standalone__gqa_softmax__near_ridge_kernel
.p2align 12
.p2align 8
.type standalone__gqa_softmax__near_ridge_kernel,@function
standalone__gqa_softmax__near_ridge_kernel:
    s_load_dwordx8 s[4:11], s[0:1], 0
    s_getpc_b64 s[46:47]
    v_mul_u32_u24 v19, 56, v0
    global_load_dword v23, v19, s[46:47]
    s_cmp_ge_u32 s2, 256
    s_cbranch_scc1 L_end
    v_lshrrev_b32 v18, 6, v0
    v_and_b32 v1, 63, v0
    v_readfirstlane_b32 s28, v18
    s_lshr_b32 s3, s2, 4
    s_lshl_b32 s3, s3, 3
    s_and_b32 s31, s2, 7
    s_or_b32 s3, s3, s31
    v_and_b32 v16, 48, v1
    v_lshlrev_b32 v16, 2, v16
    v_bfe_u32 v17, v1, 2, 2
    v_lshl_add_u32 v16, v17, 8, v16
    v_and_b32 v17, 3, v1
    v_lshl_add_u32 v2, v17, 4, v16
    v_xor_b32 v3, 16, v2
    v_xor_b32 v4, 32, v2
    v_xor_b32 v5, 48, v2
    s_lshl_b32 s29, s28, 12
    s_lshl_b32 s47, s3, 17
    s_mov_b32 s18, 131072
    s_mov_b32 s19, 0x20000
    s_mov_b32 m0, s29
    s_mov_b32 s42, 0
    s_and_b32 s42, s42, 7
    s_lshl_b32 s42, s42, 14
    s_add_u32 s32, s42, s29
    v_lshrrev_b32 v16, 3, v1
    v_lshrrev_b32 v17, 4, v1
    v_and_b32 v18, 7, v1
    v_xor_b32 v17, v17, v18
    v_lshlrev_b32 v17, 4, v17
    v_lshl_add_u32 v6, v16, 8, v17
    v_xor_b32 v7, 64, v6
    v_add_u32 v7, 0x400, v7
    s_lshl_b32 s30, s28, 13
    s_lshr_b32 s31, s2, 3
    s_and_b32 s31, s31, 1
    s_lshl_b32 s46, s3, 16
    s_lshl_b32 s31, s31, 15
    s_add_u32 s46, s46, s31
    s_add_u32 s46, s46, s30
    s_mov_b32 s14, 8192
    s_mov_b32 s15, 0x20000
    s_mov_b32 s31, 2048
    s_waitcnt lgkmcnt(0)
    s_add_u32 s16, s6, s47
    s_addc_u32 s17, s7, 0
    buffer_load_dwordx4 v2, s[16:19], s32 offen sc1 nt lds
    buffer_load_dwordx4 v5, s[16:19], s32 offen offset:1024 sc1 nt lds
    buffer_load_dwordx4 v4, s[16:19], s32 offen offset:2048 sc1 nt lds
    buffer_load_dwordx4 v3, s[16:19], s32 offen offset:3072 sc1 nt lds
    s_add_u32 s12, s4, s46
    s_addc_u32 s13, s5, 0
    s_add_u32 m0, s30, 0x20000
    s_mov_b32 s22, 131072
    buffer_load_dwordx4 v6, s[12:15], 0 offen sc1 nt lds
    buffer_load_dwordx4 v7, s[12:15], 0 offen offset:1024 sc1 nt lds
    s_add_u32 m0, s30, 0x20f80
    s_mov_b32 s23, 0x20000
    buffer_load_dwordx4 v6, s[12:15], 0 offen offset:128 sc1 nt lds
    buffer_load_dwordx4 v7, s[12:15], 0 offen offset:1152 sc1 nt lds
    s_add_u32 m0, s30, 0x20000
    s_mov_b32 s26, 8192
    buffer_load_dwordx4 v6, s[12:15], s31 offen offset:2048 sc1 nt lds
    buffer_load_dwordx4 v7, s[12:15], s31 offen offset:3072 sc1 nt lds
    s_add_u32 m0, s30, 0x20f80
    s_mov_b32 s27, 0x20000
    buffer_load_dwordx4 v6, s[12:15], s31 offen offset:2176 sc1 nt lds
    buffer_load_dwordx4 v7, s[12:15], s31 offen offset:3200 sc1 nt lds
    s_add_u32 s20, s8, s47
    s_addc_u32 s21, s9, 0
    s_add_u32 s33, s32, 0x4000
    s_and_b32 s33, s33, 0x1ffff
    s_add_u32 s34, s32, 0x8000
    s_and_b32 s34, s34, 0x1ffff
    s_add_u32 s35, s32, 0xc000
    s_and_b32 s35, s35, 0x1ffff
    s_add_u32 s36, s32, 0x10000
    s_and_b32 s36, s36, 0x1ffff
    s_add_u32 s37, s32, 0x14000
    s_and_b32 s37, s37, 0x1ffff
    s_add_u32 s38, s32, 0x18000
    s_and_b32 s38, s38, 0x1ffff
    s_add_u32 s39, s32, 0x1c000
    s_and_b32 s39, s39, 0x1ffff
    v_bfe_u32 v16, v1, 2, 2
    v_lshrrev_b32 v17, 4, v1
    v_sub_u32 v18, 4, v16
    v_and_b32 v18, 3, v18
    v_xor_b32 v18, v18, v17
    v_lshlrev_b32 v18, 4, v18
    v_lshl_add_u32 v18, v16, 10, v18
    v_and_b32 v19, 3, v1
    v_lshl_add_u32 v8, v19, 6, v18
    v_lshlrev_b32 v18, 10, v17
    v_lshl_add_u32 v18, v16, 6, v18
    v_lshl_add_u32 v18, v19, 3, v18
    v_and_b32 v19, 1, v17
    v_lshl_add_u32 v18, v19, 5, v18
    s_and_b32 s42, s28, 1
    s_lshl_b32 s31, s42, 9
    s_add_u32 s31, s31, 0x10000
    v_add_u32 v9, s31, v18
    v_xor_b32 v10, 32, v9
    v_xor_b32 v12, 0x200, v9
    v_xor_b32 v13, 0x200, v10
    v_and_b32 v16, 15, v1
    v_bfe_u32 v18, v1, 1, 3
    v_xor_b32 v18, v18, v17
    v_lshlrev_b32 v18, 4, v18
    v_lshl_add_u32 v18, v16, 7, v18
    s_add_u32 s31, s30, 0x20000
    v_add_u32 v24, s31, v18
    v_xor_b32 v25, 64, v24
    s_mul_i32 s31, s28, 9216
    v_mul_u32_u24 v16, 144, v16
    v_lshl_add_u32 v16, v17, 3, v16
    v_add_u32 v20, s31, v16
    v_add_u32 v11, 0x900, v20
    v_add_u32 v30, 0x1200, v20
    v_add_u32 v31, 0x1b00, v20
    v_lshrrev_b32 v16, 3, v1
    v_and_b32 v18, 7, v1
    v_mul_u32_u24 v19, 144, v16
    v_lshl_add_u32 v19, v18, 4, v19
    v_add_u32 v21, s31, v19
    v_lshlrev_b32 v16, 8, v16
    v_lshl_add_u32 v22, v18, 4, v16
    s_lshl_b32 s42, s42, 7
    v_add_u32 v22, s42, v22
    v_xor_b32 v26, 0x80, v22
    s_add_u32 s24, s10, s46
    s_addc_u32 s25, s11, 0
    s_mov_b32 s40, 0x3e0293ee
    s_mov_b32 s41, 0x4e800000
    s_mov_b32 s43, 4096
    v_mov_b32 v28, s40
    v_mov_b32 v29, s40
    v_and_b32 v16, 3, v1
    v_cmp_eq_u32 vcc, 0, v16
    v_mov_b32 v17, 0x3f803f80
    s_nop 0
    v_cndmask_b32 v32, 0, v17, vcc
    v_cndmask_b32 v33, 0, v17, vcc
    v_cndmask_b32 v34, 0, v17, vcc
    v_cndmask_b32 v35, 0, v17, vcc
    v_mov_b32 v36, 0
    v_mov_b32 v37, 0
    v_mov_b32 v38, 0
    v_mov_b32 v39, 0
    v_mov_b32 v40, 0
    v_mov_b32 v41, 0
    v_mov_b32 v42, 0
    v_mov_b32 v43, 0
    s_waitcnt vmcnt(8)
    s_barrier
    s_add_u32 m0, s29, 0x4000
    s_nop 0
    buffer_load_dwordx4 v2, s[16:19], s33 offen sc1 nt lds
    buffer_load_dwordx4 v5, s[16:19], s33 offen offset:1024 sc1 nt lds
    buffer_load_dwordx4 v4, s[16:19], s33 offen offset:2048 sc1 nt lds
    buffer_load_dwordx4 v3, s[16:19], s33 offen offset:3072 sc1 nt lds
    v_mov_b32 v23, s41
    ds_read_b128 a[0:3], v8
    ds_read_b128 a[16:19], v8 offset:4096
    ds_read_b128 a[32:35], v8 offset:8192
    ds_read_b128 a[48:51], v8 offset:12288
    ds_read_b128 a[4:7], v8 offset:256
    ds_read_b128 a[20:23], v8 offset:4352
    ds_read_b128 a[36:39], v8 offset:8448
    ds_read_b128 a[52:55], v8 offset:12544
    ds_read_b128 a[8:11], v8 offset:512
    ds_read_b128 a[24:27], v8 offset:4608
    ds_read_b128 a[40:43], v8 offset:8704
    ds_read_b128 a[56:59], v8 offset:12800
    ds_read_b128 a[12:15], v8 offset:768
    ds_read_b128 a[28:31], v8 offset:4864
    ds_read_b128 a[44:47], v8 offset:8960
    ds_read_b128 a[60:63], v8 offset:13056
    s_waitcnt vmcnt(10)
    ds_read_b128 v[124:127], v24
    ds_read_b128 v[132:135], v25
    s_waitcnt lgkmcnt(1)
    v_lshlrev_b32 v228, 16, v124
    v_and_b32 v229, 0xffff0000, v124
    v_lshlrev_b32 v230, 16, v125
    v_and_b32 v231, 0xffff0000, v125
    v_lshlrev_b32 v232, 16, v126
    v_and_b32 v233, 0xffff0000, v126
    v_lshlrev_b32 v234, 16, v127
    v_and_b32 v235, 0xffff0000, v127
    v_pk_mul_f32 v[228:229], v[228:229], v[28:29]
    v_pk_mul_f32 v[230:231], v[230:231], v[28:29]
    v_pk_mul_f32 v[232:233], v[232:233], v[28:29]
    v_pk_mul_f32 v[234:235], v[234:235], v[28:29]
    v_cvt_pk_bf16_f32 v124, v228, v229
    v_cvt_pk_bf16_f32 v125, v230, v231
    v_cvt_pk_bf16_f32 v126, v232, v233
    v_cvt_pk_bf16_f32 v127, v234, v235
    s_nop 1
    v_mfma_f32_16x16x32_bf16 v[76:79], a[0:3], v[124:127], 0
    s_waitcnt lgkmcnt(0)
    v_lshlrev_b32 v228, 16, v132
    v_and_b32 v229, 0xffff0000, v132
    v_lshlrev_b32 v230, 16, v133
    v_and_b32 v231, 0xffff0000, v133
    v_lshlrev_b32 v232, 16, v134
    v_mfma_f32_16x16x32_bf16 v[80:83], a[16:19], v[124:127], 0
    v_and_b32 v233, 0xffff0000, v134
    v_lshlrev_b32 v234, 16, v135
    v_and_b32 v235, 0xffff0000, v135
    v_mul_f32 v228, s40, v228
    v_mul_f32 v229, s40, v229
    v_mfma_f32_16x16x32_bf16 v[92:95], a[32:35], v[124:127], 0
    v_mul_f32 v230, s40, v230
    v_mul_f32 v231, s40, v231
    v_mul_f32 v232, s40, v232
    v_mul_f32 v233, s40, v233
    v_mul_f32 v234, s40, v234
    v_mfma_f32_16x16x32_bf16 v[96:99], a[48:51], v[124:127], 0
    v_mul_f32 v235, s40, v235
    v_cvt_pk_bf16_f32 v132, v228, v229
    v_cvt_pk_bf16_f32 v133, v230, v231
    v_cvt_pk_bf16_f32 v134, v232, v233
    v_cvt_pk_bf16_f32 v135, v234, v235
    s_nop 1
    v_mfma_f32_16x16x32_bf16 v[76:79], a[4:7], v[132:135], v[76:79]
    v_mfma_f32_16x16x32_bf16 v[80:83], a[20:23], v[132:135], v[80:83]
    v_mfma_f32_16x16x32_bf16 v[92:95], a[36:39], v[132:135], v[92:95]
    v_mfma_f32_16x16x32_bf16 v[96:99], a[52:55], v[132:135], v[96:99]
    s_mov_b64 exec, 0
    s_cmp_eq_u32 s28, 0
    s_cbranch_scc1 L_stub0
    s_cmp_eq_u32 s28, 1
    s_cbranch_scc1 L_stub1
    s_cmp_eq_u32 s28, 2
    s_cbranch_scc1 L_stub2
    s_nop 0
L_stubret:
    s_mov_b64 exec, -1
    s_waitcnt vmcnt(8)
    ds_read_b128 v[140:143], v24 offset:4096
    ds_read_b128 v[148:151], v25 offset:4096
    s_add_u32 m0, s29, 0x10000
    s_nop 0
    buffer_load_dwordx4 v2, s[20:23], s32 offen sc1 nt lds
    buffer_load_dwordx4 v4, s[20:23], s32 offen offset:1024 sc1 nt lds
    buffer_load_dwordx4 v2, s[20:23], s32 offen offset:2048 sc1 nt lds
    buffer_load_dwordx4 v4, s[20:23], s32 offen offset:3072 sc1 nt lds
    s_waitcnt lgkmcnt(1)
    v_lshlrev_b32 v228, 16, v140
    v_and_b32 v229, 0xffff0000, v140
    v_lshlrev_b32 v230, 16, v141
    v_and_b32 v231, 0xffff0000, v141
    v_lshlrev_b32 v232, 16, v142
    v_and_b32 v233, 0xffff0000, v142
    v_lshlrev_b32 v234, 16, v143
    v_and_b32 v235, 0xffff0000, v143
    v_pk_mul_f32 v[228:229], v[228:229], v[28:29]
    v_pk_mul_f32 v[230:231], v[230:231], v[28:29]
    v_pk_mul_f32 v[232:233], v[232:233], v[28:29]
    v_pk_mul_f32 v[234:235], v[234:235], v[28:29]
    v_cvt_pk_bf16_f32 v140, v228, v229
    v_cvt_pk_bf16_f32 v141, v230, v231
    v_cvt_pk_bf16_f32 v142, v232, v233
    v_cvt_pk_bf16_f32 v143, v234, v235
    s_nop 1
    v_mfma_f32_16x16x32_bf16 v[76:79], a[8:11], v[140:143], v[76:79]
    s_waitcnt lgkmcnt(0)
    v_lshlrev_b32 v228, 16, v148
    v_and_b32 v229, 0xffff0000, v148
    v_lshlrev_b32 v230, 16, v149
    v_and_b32 v231, 0xffff0000, v149
    v_lshlrev_b32 v232, 16, v150
    v_mfma_f32_16x16x32_bf16 v[80:83], a[24:27], v[140:143], v[80:83]
    v_and_b32 v233, 0xffff0000, v150
    v_lshlrev_b32 v234, 16, v151
    v_and_b32 v235, 0xffff0000, v151
    v_mul_f32 v228, s40, v228
    v_mul_f32 v229, s40, v229
    v_mfma_f32_16x16x32_bf16 v[92:95], a[40:43], v[140:143], v[92:95]
    v_mul_f32 v230, s40, v230
    v_mul_f32 v231, s40, v231
    v_mul_f32 v232, s40, v232
    v_mul_f32 v233, s40, v233
    v_mul_f32 v234, s40, v234
    v_mfma_f32_16x16x32_bf16 v[96:99], a[56:59], v[140:143], v[96:99]
    v_mul_f32 v235, s40, v235
    v_cvt_pk_bf16_f32 v148, v228, v229
    v_cvt_pk_bf16_f32 v149, v230, v231
    v_cvt_pk_bf16_f32 v150, v232, v233
    v_cvt_pk_bf16_f32 v151, v234, v235
    s_nop 1
    v_mfma_f32_16x16x32_bf16 v[76:79], a[12:15], v[148:151], v[76:79]
    v_mfma_f32_16x16x32_bf16 v[80:83], a[28:31], v[148:151], v[80:83]
    v_mfma_f32_16x16x32_bf16 v[92:95], a[44:47], v[148:151], v[92:95]
    v_mfma_f32_16x16x32_bf16 v[96:99], a[60:63], v[148:151], v[96:99]
    s_nop 4
    v_max3_f32 v16, v76, v77, v78
    v_max3_f32 v16, v16, v79, v80
    v_max3_f32 v16, v16, v81, v82
    v_max_f32 v16, v16, v83
    v_mov_b32 v17, v16
    s_nop 1
    v_permlane32_swap_b32 v16, v17
    v_max_f32 v16, v16, v17
    v_mov_b32 v17, v16
    s_nop 1
    v_permlane16_swap_b32 v16, v17
    v_max_f32 v16, v16, v17
    v_sub_f32 v44, 0, v16
    v_sub_f32 v45, 0, v16
    v_sub_f32 v46, 0, v16
    v_sub_f32 v47, 0, v16
    v_add_f32 v76, v76, v44
    v_add_f32 v77, v77, v44
    v_add_f32 v78, v78, v44
    v_add_f32 v79, v79, v44
    v_exp_f32 v76, v76
    v_exp_f32 v77, v77
    v_exp_f32 v78, v78
    v_exp_f32 v79, v79
    v_cvt_pk_bf16_f32 v52, v76, v77
    v_cvt_pk_bf16_f32 v53, v78, v79
    v_add_f32 v80, v80, v44
    v_add_f32 v81, v81, v44
    v_add_f32 v82, v82, v44
    v_add_f32 v83, v83, v44
    v_exp_f32 v80, v80
    v_exp_f32 v81, v81
    v_exp_f32 v82, v82
    v_exp_f32 v83, v83
    v_cvt_pk_bf16_f32 v54, v80, v81
    v_cvt_pk_bf16_f32 v55, v82, v83
    v_add_f32 v92, v92, v44
    v_add_f32 v93, v93, v44
    v_add_f32 v94, v94, v44
    v_add_f32 v95, v95, v44
    v_exp_f32 v92, v92
    v_exp_f32 v93, v93
    v_exp_f32 v94, v94
    v_exp_f32 v95, v95
    v_cvt_pk_bf16_f32 v60, v92, v93
    v_cvt_pk_bf16_f32 v61, v94, v95
    v_add_f32 v96, v96, v44
    v_add_f32 v97, v97, v44
    v_add_f32 v98, v98, v44
    v_add_f32 v99, v99, v44
    v_exp_f32 v96, v96
    v_exp_f32 v97, v97
    v_exp_f32 v98, v98
    v_exp_f32 v99, v99
    v_cvt_pk_bf16_f32 v62, v96, v97
    v_cvt_pk_bf16_f32 v63, v98, v99
    s_waitcnt vmcnt(10)
    ds_read_b128 v[128:131], v24 offset:2048
    ds_read_b128 v[136:139], v25 offset:2048
    s_waitcnt lgkmcnt(1)
    v_lshlrev_b32 v220, 16, v128
    v_and_b32 v221, 0xffff0000, v128
    v_lshlrev_b32 v222, 16, v129
    v_and_b32 v223, 0xffff0000, v129
    v_lshlrev_b32 v224, 16, v130
    v_and_b32 v225, 0xffff0000, v130
    v_lshlrev_b32 v226, 16, v131
    v_and_b32 v227, 0xffff0000, v131
    v_pk_mul_f32 v[220:221], v[220:221], v[28:29]
    v_pk_mul_f32 v[222:223], v[222:223], v[28:29]
    v_pk_mul_f32 v[224:225], v[224:225], v[28:29]
    v_pk_mul_f32 v[226:227], v[226:227], v[28:29]
    v_cvt_pk_bf16_f32 v128, v220, v221
    v_cvt_pk_bf16_f32 v129, v222, v223
    v_cvt_pk_bf16_f32 v130, v224, v225
    v_cvt_pk_bf16_f32 v131, v226, v227
    s_nop 1
    v_mfma_f32_16x16x32_bf16 v[84:87], a[0:3], v[128:131], 0
    s_waitcnt lgkmcnt(0)
    v_lshlrev_b32 v220, 16, v136
    v_and_b32 v221, 0xffff0000, v136
    v_lshlrev_b32 v222, 16, v137
    v_and_b32 v223, 0xffff0000, v137
    v_lshlrev_b32 v224, 16, v138
    v_mfma_f32_16x16x32_bf16 v[88:91], a[16:19], v[128:131], 0
    v_and_b32 v225, 0xffff0000, v138
    v_lshlrev_b32 v226, 16, v139
    v_and_b32 v227, 0xffff0000, v139
    v_mul_f32 v220, s40, v220
    v_mul_f32 v221, s40, v221
    v_mfma_f32_16x16x32_bf16 v[100:103], a[32:35], v[128:131], 0
    v_mul_f32 v222, s40, v222
    v_mul_f32 v223, s40, v223
    v_mul_f32 v224, s40, v224
    v_mul_f32 v225, s40, v225
    v_mul_f32 v226, s40, v226
    v_mfma_f32_16x16x32_bf16 v[104:107], a[48:51], v[128:131], 0
    v_mul_f32 v227, s40, v227
    v_cvt_pk_bf16_f32 v136, v220, v221
    v_cvt_pk_bf16_f32 v137, v222, v223
    v_cvt_pk_bf16_f32 v138, v224, v225
    v_cvt_pk_bf16_f32 v139, v226, v227
    s_nop 1
    v_mfma_f32_16x16x32_bf16 v[84:87], a[4:7], v[136:139], v[84:87]
    v_mfma_f32_16x16x32_bf16 v[88:91], a[20:23], v[136:139], v[88:91]
    v_mfma_f32_16x16x32_bf16 v[100:103], a[36:39], v[136:139], v[100:103]
    v_mfma_f32_16x16x32_bf16 v[104:107], a[52:55], v[136:139], v[104:107]
    s_waitcnt vmcnt(8)
    ds_read_b128 v[144:147], v24 offset:6144
    ds_read_b128 v[152:155], v25 offset:6144
    s_add_u32 m0, s29, 0x8000
    s_nop 0
    buffer_load_dwordx4 v2, s[16:19], s34 offen sc1 nt lds
    buffer_load_dwordx4 v5, s[16:19], s34 offen offset:1024 sc1 nt lds
    buffer_load_dwordx4 v4, s[16:19], s34 offen offset:2048 sc1 nt lds
    buffer_load_dwordx4 v3, s[16:19], s34 offen offset:3072 sc1 nt lds
    s_waitcnt lgkmcnt(1)
    v_lshlrev_b32 v220, 16, v144
    v_and_b32 v221, 0xffff0000, v144
    v_lshlrev_b32 v222, 16, v145
    v_and_b32 v223, 0xffff0000, v145
    v_lshlrev_b32 v224, 16, v146
    v_and_b32 v225, 0xffff0000, v146
    v_lshlrev_b32 v226, 16, v147
    v_and_b32 v227, 0xffff0000, v147
    v_pk_mul_f32 v[220:221], v[220:221], v[28:29]
    v_pk_mul_f32 v[222:223], v[222:223], v[28:29]
    v_pk_mul_f32 v[224:225], v[224:225], v[28:29]
    v_pk_mul_f32 v[226:227], v[226:227], v[28:29]
    v_cvt_pk_bf16_f32 v144, v220, v221
    v_cvt_pk_bf16_f32 v145, v222, v223
    v_cvt_pk_bf16_f32 v146, v224, v225
    v_cvt_pk_bf16_f32 v147, v226, v227
    s_nop 1
    v_mfma_f32_16x16x32_bf16 v[84:87], a[8:11], v[144:147], v[84:87]
    s_waitcnt lgkmcnt(0)
    v_lshlrev_b32 v220, 16, v152
    v_and_b32 v221, 0xffff0000, v152
    v_lshlrev_b32 v222, 16, v153
    v_and_b32 v223, 0xffff0000, v153
    v_lshlrev_b32 v224, 16, v154
    v_mfma_f32_16x16x32_bf16 v[88:91], a[24:27], v[144:147], v[88:91]
    v_and_b32 v225, 0xffff0000, v154
    v_lshlrev_b32 v226, 16, v155
    v_and_b32 v227, 0xffff0000, v155
    v_mul_f32 v220, s40, v220
    v_mul_f32 v221, s40, v221
    v_mfma_f32_16x16x32_bf16 v[100:103], a[40:43], v[144:147], v[100:103]
    v_mul_f32 v222, s40, v222
    v_mul_f32 v223, s40, v223
    v_mul_f32 v224, s40, v224
    v_mul_f32 v225, s40, v225
    v_mul_f32 v226, s40, v226
    v_mfma_f32_16x16x32_bf16 v[104:107], a[56:59], v[144:147], v[104:107]
    v_mul_f32 v227, s40, v227
    v_cvt_pk_bf16_f32 v152, v220, v221
    v_cvt_pk_bf16_f32 v153, v222, v223
    v_cvt_pk_bf16_f32 v154, v224, v225
    v_cvt_pk_bf16_f32 v155, v226, v227
    s_nop 1
    v_mfma_f32_16x16x32_bf16 v[84:87], a[12:15], v[152:155], v[84:87]
    v_mfma_f32_16x16x32_bf16 v[88:91], a[28:31], v[152:155], v[88:91]
    v_mfma_f32_16x16x32_bf16 v[100:103], a[44:47], v[152:155], v[100:103]
    v_mfma_f32_16x16x32_bf16 v[104:107], a[60:63], v[152:155], v[104:107]
    s_nop 4
    v_max3_f32 v16, v84, v85, v86
    v_max3_f32 v16, v16, v87, v88
    v_max3_f32 v16, v16, v89, v90
    v_max_f32 v16, v16, v91
    v_mov_b32 v17, v16
    s_nop 1
    v_permlane32_swap_b32 v16, v17
    v_max_f32 v16, v16, v17
    v_mov_b32 v17, v16
    s_nop 1
    v_permlane16_swap_b32 v16, v17
    v_max_f32 v16, v16, v17
    v_sub_f32 v48, 0, v16
    v_sub_f32 v49, 0, v16
    v_sub_f32 v50, 0, v16
    v_sub_f32 v51, 0, v16
    v_add_f32 v84, v84, v48
    v_add_f32 v85, v85, v48
    v_add_f32 v86, v86, v48
    v_add_f32 v87, v87, v48
    v_exp_f32 v84, v84
    v_exp_f32 v85, v85
    v_exp_f32 v86, v86
    v_exp_f32 v87, v87
    v_cvt_pk_bf16_f32 v56, v84, v85
    v_cvt_pk_bf16_f32 v57, v86, v87
    v_add_f32 v88, v88, v48
    v_add_f32 v89, v89, v48
    v_add_f32 v90, v90, v48
    v_add_f32 v91, v91, v48
    v_exp_f32 v88, v88
    v_exp_f32 v89, v89
    v_exp_f32 v90, v90
    v_exp_f32 v91, v91
    s_waitcnt vmcnt(8)
    s_barrier
    ds_read_b128 a[0:3], v8 offset:16384
    ds_read_b128 a[4:7], v8 offset:16640
    ds_read_b128 a[8:11], v8 offset:16896
    ds_read_b128 a[12:15], v8 offset:17152
    v_cvt_pk_bf16_f32 v58, v88, v89
    v_cvt_pk_bf16_f32 v59, v90, v91
    v_add_f32 v100, v100, v48
    v_add_f32 v101, v101, v48
    v_add_f32 v102, v102, v48
    v_add_f32 v103, v103, v48
    v_exp_f32 v100, v100
    v_exp_f32 v101, v101
    v_exp_f32 v102, v102
    v_exp_f32 v103, v103
    v_cvt_pk_bf16_f32 v64, v100, v101
    v_cvt_pk_bf16_f32 v65, v102, v103
    v_add_f32 v104, v104, v48
    v_add_f32 v105, v105, v48
    v_add_f32 v106, v106, v48
    v_add_f32 v107, v107, v48
    v_exp_f32 v104, v104
    v_exp_f32 v105, v105
    s_waitcnt lgkmcnt(3)
    v_mfma_f32_16x16x32_bf16 v[108:111], a[0:3], v[124:127], v[44:47]
    s_waitcnt lgkmcnt(3)
    ds_read_b128 a[16:19], v8 offset:20480
    ds_read_b128 a[20:23], v8 offset:20736
    v_mfma_f32_16x16x32_bf16 v[116:119], a[0:3], v[128:131], v[48:51]
    s_waitcnt lgkmcnt(4)
    ds_read_b128 a[24:27], v8 offset:20992
    ds_read_b128 a[28:31], v8 offset:21248
    v_mfma_f32_16x16x32_bf16 v[108:111], a[4:7], v[132:135], v[108:111]
    s_add_u32 m0, s29, 0x14000
    ds_read_b128 a[32:35], v8 offset:24576
    buffer_load_dwordx4 v2, s[20:23], s33 offen sc1 nt lds
    v_mfma_f32_16x16x32_bf16 v[116:119], a[4:7], v[136:139], v[116:119]
    s_waitcnt lgkmcnt(6)
    v_exp_f32 v106, v106
    v_mfma_f32_16x16x32_bf16 v[108:111], a[8:11], v[140:143], v[108:111]
    v_exp_f32 v107, v107
    v_mfma_f32_16x16x32_bf16 v[116:119], a[8:11], v[144:147], v[116:119]
    s_waitcnt lgkmcnt(5)
    buffer_load_dwordx4 v4, s[20:23], s33 offen offset:1024 sc1 nt lds
    v_mfma_f32_16x16x32_bf16 v[108:111], a[12:15], v[148:151], v[108:111]
    ds_read_b128 a[36:39], v8 offset:24832
    v_cvt_pk_bf16_f32 v66, v104, v105
    v_mfma_f32_16x16x32_bf16 v[116:119], a[12:15], v[152:155], v[116:119]
    s_waitcnt lgkmcnt(5)
    ds_read_b128 a[40:43], v8 offset:25088
    v_cvt_pk_bf16_f32 v67, v106, v107
    v_mfma_f32_16x16x32_bf16 v[112:115], a[16:19], v[124:127], v[44:47]
    buffer_load_dwordx4 v2, s[20:23], s33 offen offset:2048 sc1 nt lds
    v_mfma_f32_16x16x32_bf16 v[120:123], a[16:19], v[128:131], v[48:51]
    s_waitcnt lgkmcnt(5)
    v_exp_f32 v108, v108
    v_mfma_f32_16x16x32_bf16 v[112:115], a[20:23], v[132:135], v[112:115]
    v_exp_f32 v109, v109
    v_mfma_f32_16x16x32_bf16 v[120:123], a[20:23], v[136:139], v[120:123]
    s_waitcnt lgkmcnt(4)
    buffer_load_dwordx4 v4, s[20:23], s33 offen offset:3072 sc1 nt lds
    v_mfma_f32_16x16x32_bf16 v[112:115], a[24:27], v[140:143], v[112:115]
    v_exp_f32 v110, v110
    v_mfma_f32_16x16x32_bf16 v[120:123], a[24:27], v[144:147], v[120:123]
    s_waitcnt lgkmcnt(3)
    v_exp_f32 v111, v111
    v_mfma_f32_16x16x32_bf16 v[112:115], a[28:31], v[148:151], v[112:115]
    ds_read_b128 a[44:47], v8 offset:25344
    v_cvt_pk_bf16_f32 v68, v108, v109
    v_mfma_f32_16x16x32_bf16 v[120:123], a[28:31], v[152:155], v[120:123]
    s_waitcnt lgkmcnt(3)
    ds_read_b128 a[48:51], v8 offset:28672
    v_cvt_pk_bf16_f32 v69, v110, v111
    v_mfma_f32_16x16x32_bf16 v[76:79], a[32:35], v[124:127], v[44:47]
    s_add_u32 m0, s29, 0xc000
    ds_read_b128 a[52:55], v8 offset:28928
    buffer_load_dwordx4 v2, s[16:19], s35 offen sc1 nt lds
    v_mfma_f32_16x16x32_bf16 v[84:87], a[32:35], v[128:131], v[48:51]
    s_waitcnt lgkmcnt(4)
    v_exp_f32 v116, v116
    v_mfma_f32_16x16x32_bf16 v[76:79], a[36:39], v[132:135], v[76:79]
    ds_read_b128 a[56:59], v8 offset:29184
    ds_read_b128 a[60:63], v8 offset:29440
    v_mfma_f32_16x16x32_bf16 v[84:87], a[36:39], v[136:139], v[84:87]
    s_waitcnt lgkmcnt(5)
    buffer_load_dwordx4 v5, s[16:19], s35 offen offset:1024 sc1 nt lds
    v_mfma_f32_16x16x32_bf16 v[76:79], a[40:43], v[140:143], v[76:79]
    v_exp_f32 v117, v117
    v_mfma_f32_16x16x32_bf16 v[84:87], a[40:43], v[144:147], v[84:87]
    s_waitcnt lgkmcnt(4)
    v_exp_f32 v118, v118
    v_mfma_f32_16x16x32_bf16 v[76:79], a[44:47], v[148:151], v[76:79]
    buffer_load_dwordx4 v4, s[16:19], s35 offen offset:2048 sc1 nt lds
    v_mfma_f32_16x16x32_bf16 v[84:87], a[44:47], v[152:155], v[84:87]
    s_waitcnt vmcnt(11) lgkmcnt(3)
    s_barrier
    v_mfma_f32_16x16x32_bf16 v[80:83], a[48:51], v[124:127], v[44:47]
    ds_read_b64_tr_b16 a[64:65], v9
    ds_read_b64_tr_b16 a[66:67], v9 offset:4096
    v_mfma_f32_16x16x32_bf16 v[88:91], a[48:51], v[128:131], v[48:51]
    s_waitcnt lgkmcnt(4)
    buffer_load_dwordx4 v3, s[16:19], s35 offen offset:3072 sc1 nt lds
    v_mfma_f32_16x16x32_bf16 v[80:83], a[52:55], v[132:135], v[80:83]
    ds_read_b64_tr_b16 a[68:69], v10
    ds_read_b64_tr_b16 a[70:71], v10 offset:4096
    v_mfma_f32_16x16x32_bf16 v[88:91], a[52:55], v[136:139], v[88:91]
    s_waitcnt lgkmcnt(5)
    v_exp_f32 v119, v119
    v_mfma_f32_16x16x32_bf16 v[80:83], a[56:59], v[140:143], v[80:83]
    ds_read_b64_tr_b16 a[72:73], v9 offset:256
    ds_read_b64_tr_b16 a[74:75], v9 offset:4352
    v_mfma_f32_16x16x32_bf16 v[88:91], a[56:59], v[144:147], v[88:91]
    s_waitcnt lgkmcnt(6)
    ds_read_b64_tr_b16 a[76:77], v10 offset:256
    v_cvt_pk_bf16_f32 v72, v116, v117
    v_mfma_f32_16x16x32_bf16 v[80:83], a[60:63], v[148:151], v[80:83]
    ds_read_b64_tr_b16 a[78:79], v10 offset:4352
    v_cvt_pk_bf16_f32 v73, v118, v119
    v_mfma_f32_16x16x32_bf16 v[88:91], a[60:63], v[152:155], v[88:91]
    s_waitcnt lgkmcnt(6)
    ds_read_b64_tr_b16 a[80:81], v12
    ds_read_b64_tr_b16 a[82:83], v12 offset:4096
    v_mfma_f32_16x16x32_bf16 v[156:159], a[64:67], v[52:55], 0
    s_add_u32 m0, s29, 0x18000
    ds_read_b64_tr_b16 a[84:85], v13
    buffer_load_dwordx4 v2, s[20:23], s34 offen sc1 nt lds
    v_mfma_f32_16x16x32_bf16 v[188:191], a[64:67], v[56:59], 0
    s_waitcnt lgkmcnt(7)
    v_exp_f32 v112, v112
    v_mfma_f32_16x16x32_bf16 v[160:163], a[68:71], v[52:55], 0
    ds_read_b64_tr_b16 a[86:87], v13 offset:4096
    ds_read_b64_tr_b16 a[88:89], v12 offset:256
    v_mfma_f32_16x16x32_bf16 v[192:195], a[68:71], v[56:59], 0
    s_waitcnt lgkmcnt(7)
    buffer_load_dwordx4 v4, s[20:23], s34 offen offset:1024 sc1 nt lds
    v_mfma_f32_16x16x32_bf16 v[164:167], a[72:75], v[52:55], 0
    ds_read_b64_tr_b16 a[90:91], v12 offset:4352
    ds_read_b64_tr_b16 a[92:93], v13 offset:256
    v_mfma_f32_16x16x32_bf16 v[196:199], a[72:75], v[56:59], 0
    s_waitcnt lgkmcnt(7)
    v_exp_f32 v113, v113
    v_mfma_f32_16x16x32_bf16 v[168:171], a[76:79], v[52:55], 0
    ds_read_b64_tr_b16 a[94:95], v13 offset:4352
    ds_read_b64_tr_b16 a[96:97], v9 offset:8192
    v_mfma_f32_16x16x32_bf16 v[200:203], a[76:79], v[56:59], 0
    s_waitcnt lgkmcnt(7)
    buffer_load_dwordx4 v2, s[20:23], s34 offen offset:2048 sc1 nt lds
    v_mfma_f32_16x16x32_bf16 v[172:175], a[80:83], v[52:55], 0
    ds_read_b64_tr_b16 a[98:99], v9 offset:12288
    ds_read_b64_tr_b16 a[100:101], v10 offset:8192
    v_mfma_f32_16x16x32_bf16 v[204:207], a[80:83], v[56:59], 0
    s_waitcnt lgkmcnt(7)
    v_exp_f32 v114, v114
    v_mfma_f32_16x16x32_bf16 v[176:179], a[84:87], v[52:55], 0
    buffer_load_dwordx4 v4, s[20:23], s34 offen offset:3072 sc1 nt lds
    v_mfma_f32_16x16x32_bf16 v[208:211], a[84:87], v[56:59], 0
    s_waitcnt lgkmcnt(5)
    ds_read_b64_tr_b16 a[102:103], v10 offset:12288
    ds_read_b64_tr_b16 a[104:105], v9 offset:8448
    v_mfma_f32_16x16x32_bf16 v[180:183], a[88:91], v[52:55], 0
    v_exp_f32 v115, v115
    v_mfma_f32_16x16x32_bf16 v[212:215], a[88:91], v[56:59], 0
    s_waitcnt lgkmcnt(5)
    ds_read_b64_tr_b16 a[106:107], v9 offset:12544
    v_cvt_pk_bf16_f32 v70, v112, v113
    v_mfma_f32_16x16x32_bf16 v[184:187], a[92:95], v[52:55], 0
    ds_read_b64_tr_b16 a[108:109], v10 offset:8448
    v_cvt_pk_bf16_f32 v71, v114, v115
    v_mfma_f32_16x16x32_bf16 v[216:219], a[92:95], v[56:59], 0
L_stub0:
    s_cbranch_execz L_stubret
    ds_read_b64_tr_b16 a[110:111], v10 offset:12544
    ds_read_b64_tr_b16 a[112:113], v12 offset:8192
    v_mfma_f32_16x16x32_bf16 v[36:39], v[32:35], v[52:55], v[36:39]
    v_exp_f32 v120, v120
    v_mfma_f32_16x16x32_bf16 v[40:43], v[32:35], v[56:59], v[40:43]
    s_waitcnt lgkmcnt(7)
    ds_read_b64_tr_b16 a[114:115], v12 offset:12288
    ds_read_b64_tr_b16 a[116:117], v13 offset:8192
    v_mfma_f32_16x16x32_bf16 v[156:159], a[96:99], v[60:63], v[156:159]
    v_exp_f32 v121, v121
    v_mfma_f32_16x16x32_bf16 v[188:191], a[96:99], v[64:67], v[188:191]
    s_waitcnt lgkmcnt(7)
    v_exp_f32 v122, v122
    v_mfma_f32_16x16x32_bf16 v[160:163], a[100:103], v[60:63], v[160:163]
    ds_read_b64_tr_b16 a[118:119], v13 offset:12288
    ds_read_b64_tr_b16 a[120:121], v12 offset:8448
    v_mfma_f32_16x16x32_bf16 v[192:195], a[100:103], v[64:67], v[192:195]
    s_waitcnt lgkmcnt(7)
    v_exp_f32 v123, v123
    v_mfma_f32_16x16x32_bf16 v[164:167], a[104:107], v[60:63], v[164:167]
    ds_read_b64_tr_b16 a[122:123], v12 offset:12544
    v_cvt_pk_bf16_f32 v74, v120, v121
    v_mfma_f32_16x16x32_bf16 v[196:199], a[104:107], v[64:67], v[196:199]
    s_waitcnt lgkmcnt(6)
    ds_read_b64_tr_b16 a[124:125], v13 offset:8448
    v_cvt_pk_bf16_f32 v75, v122, v123
    v_mfma_f32_16x16x32_bf16 v[168:171], a[108:111], v[60:63], v[168:171]
    ds_read_b64_tr_b16 a[126:127], v13 offset:12544
    v_exp_f32 v76, v76
    v_mfma_f32_16x16x32_bf16 v[200:203], a[108:111], v[64:67], v[200:203]
    s_waitcnt lgkmcnt(6)
    v_exp_f32 v77, v77
    v_mfma_f32_16x16x32_bf16 v[172:175], a[112:115], v[60:63], v[172:175]
    v_exp_f32 v78, v78
    v_mfma_f32_16x16x32_bf16 v[204:207], a[112:115], v[64:67], v[204:207]
    s_waitcnt vmcnt(12) lgkmcnt(4)
    s_barrier
    v_mfma_f32_16x16x32_bf16 v[176:179], a[116:119], v[60:63], v[176:179]
    ds_read_b128 a[0:3], v8 offset:32768
    ds_read_b128 a[4:7], v8 offset:33024
    v_mfma_f32_16x16x32_bf16 v[208:211], a[116:119], v[64:67], v[208:211]
    s_waitcnt lgkmcnt(4)
    v_exp_f32 v79, v79
    v_mfma_f32_16x16x32_bf16 v[180:183], a[120:123], v[60:63], v[180:183]
    s_add_u32 m0, s29, 0x0
    ds_read_b128 a[8:11], v8 offset:33280
    buffer_load_dwordx4 v2, s[16:19], s36 offen sc1 nt lds
    v_mfma_f32_16x16x32_bf16 v[212:215], a[120:123], v[64:67], v[212:215]
    s_waitcnt lgkmcnt(3)
    ds_read_b128 a[12:15], v8 offset:33536
    v_cvt_pk_bf16_f32 v220, v76, v77
    v_mfma_f32_16x16x32_bf16 v[184:187], a[124:127], v[60:63], v[184:187]
    ds_read_b128 a[16:19], v8 offset:36864
    v_cvt_pk_bf16_f32 v221, v78, v79
    v_mfma_f32_16x16x32_bf16 v[216:219], a[124:127], v[64:67], v[216:219]
    v_exp_f32 v84, v84
    v_mfma_f32_16x16x32_bf16 v[36:39], v[32:35], v[60:63], v[36:39]
    v_exp_f32 v85, v85
    v_mfma_f32_16x16x32_bf16 v[40:43], v[32:35], v[64:67], v[40:43]
    s_waitcnt lgkmcnt(4)
    v_exp_f32 v86, v86
    v_mfma_f32_16x16x32_bf16 v[92:95], a[0:3], v[124:127], v[44:47]
    v_exp_f32 v87, v87
    v_mfma_f32_16x16x32_bf16 v[100:103], a[0:3], v[128:131], v[48:51]
    s_waitcnt lgkmcnt(3)
    buffer_load_dwordx4 v5, s[16:19], s36 offen offset:1024 sc1 nt lds
    v_mfma_f32_16x16x32_bf16 v[92:95], a[4:7], v[132:135], v[92:95]
    ds_read_b128 a[20:23], v8 offset:37120
    v_cvt_pk_bf16_f32 v224, v84, v85
    v_mfma_f32_16x16x32_bf16 v[100:103], a[4:7], v[136:139], v[100:103]
    s_waitcnt lgkmcnt(3)
    ds_read_b128 a[24:27], v8 offset:37376
    v_cvt_pk_bf16_f32 v225, v86, v87
    v_mfma_f32_16x16x32_bf16 v[92:95], a[8:11], v[140:143], v[92:95]
    v_exp_f32 v80, v80
    v_mfma_f32_16x16x32_bf16 v[100:103], a[8:11], v[144:147], v[100:103]
    s_waitcnt lgkmcnt(3)
    v_exp_f32 v81, v81
    v_mfma_f32_16x16x32_bf16 v[92:95], a[12:15], v[148:151], v[92:95]
    ds_read_b128 a[28:31], v8 offset:37632
    ds_read_b128 a[32:35], v8 offset:40960
    v_mfma_f32_16x16x32_bf16 v[100:103], a[12:15], v[152:155], v[100:103]
    s_waitcnt lgkmcnt(4)
    v_exp_f32 v82, v82
    v_mfma_f32_16x16x32_bf16 v[96:99], a[16:19], v[124:127], v[44:47]
    buffer_load_dwordx4 v4, s[16:19], s36 offen offset:2048 sc1 nt lds
    v_mfma_f32_16x16x32_bf16 v[104:107], a[16:19], v[128:131], v[48:51]
    s_waitcnt lgkmcnt(3)
    v_exp_f32 v83, v83
    v_mfma_f32_16x16x32_bf16 v[96:99], a[20:23], v[132:135], v[96:99]
    ds_read_b128 a[36:39], v8 offset:41216
    v_cvt_pk_bf16_f32 v222, v80, v81
    v_mfma_f32_16x16x32_bf16 v[104:107], a[20:23], v[136:139], v[104:107]
    s_waitcnt lgkmcnt(3)
    ds_read_b128 a[40:43], v8 offset:41472
    v_cvt_pk_bf16_f32 v223, v82, v83
    v_mfma_f32_16x16x32_bf16 v[96:99], a[24:27], v[140:143], v[96:99]
    v_exp_f32 v88, v88
    v_mfma_f32_16x16x32_bf16 v[104:107], a[24:27], v[144:147], v[104:107]
    s_waitcnt lgkmcnt(3)
    v_exp_f32 v89, v89
    v_mfma_f32_16x16x32_bf16 v[96:99], a[28:31], v[148:151], v[96:99]
    ds_read_b128 a[44:47], v8 offset:41728
    ds_read_b128 a[48:51], v8 offset:45056
    v_mfma_f32_16x16x32_bf16 v[104:107], a[28:31], v[152:155], v[104:107]
    s_waitcnt lgkmcnt(4)
    buffer_load_dwordx4 v3, s[16:19], s36 offen offset:3072 sc1 nt lds
    v_mfma_f32_16x16x32_bf16 v[108:111], a[32:35], v[124:127], v[44:47]
    v_exp_f32 v90, v90
    v_mfma_f32_16x16x32_bf16 v[116:119], a[32:35], v[128:131], v[48:51]
    s_waitcnt lgkmcnt(3)
    v_exp_f32 v91, v91
    v_mfma_f32_16x16x32_bf16 v[108:111], a[36:39], v[132:135], v[108:111]
    ds_read_b128 a[52:55], v8 offset:45312
    v_cvt_pk_bf16_f32 v226, v88, v89
    v_mfma_f32_16x16x32_bf16 v[116:119], a[36:39], v[136:139], v[116:119]
    s_waitcnt lgkmcnt(3)
    ds_read_b128 a[56:59], v8 offset:45568
    v_cvt_pk_bf16_f32 v227, v90, v91
    v_mfma_f32_16x16x32_bf16 v[108:111], a[40:43], v[140:143], v[108:111]
    ds_read_b128 a[60:63], v8 offset:45824
    v_exp_f32 v92, v92
    v_mfma_f32_16x16x32_bf16 v[116:119], a[40:43], v[144:147], v[116:119]
    s_waitcnt lgkmcnt(4)
    v_exp_f32 v93, v93
    v_mfma_f32_16x16x32_bf16 v[108:111], a[44:47], v[148:151], v[108:111]
    v_exp_f32 v94, v94
    v_mfma_f32_16x16x32_bf16 v[116:119], a[44:47], v[152:155], v[116:119]
    s_waitcnt vmcnt(12) lgkmcnt(3)
    s_barrier
    v_mfma_f32_16x16x32_bf16 v[112:115], a[48:51], v[124:127], v[44:47]
    ds_read_b64_tr_b16 a[64:65], v9 offset:16384
    ds_read_b64_tr_b16 a[66:67], v9 offset:20480
    v_mfma_f32_16x16x32_bf16 v[120:123], a[48:51], v[128:131], v[48:51]
    s_waitcnt lgkmcnt(4)
    v_exp_f32 v95, v95
    v_mfma_f32_16x16x32_bf16 v[112:115], a[52:55], v[132:135], v[112:115]
    ds_read_b64_tr_b16 a[68:69], v10 offset:16384
    ds_read_b64_tr_b16 a[70:71], v10 offset:20480
    v_mfma_f32_16x16x32_bf16 v[120:123], a[52:55], v[136:139], v[120:123]
    s_waitcnt lgkmcnt(5)
    ds_read_b64_tr_b16 a[72:73], v9 offset:16640
    v_cvt_pk_bf16_f32 v228, v92, v93
    v_mfma_f32_16x16x32_bf16 v[112:115], a[56:59], v[140:143], v[112:115]
    ds_read_b64_tr_b16 a[74:75], v9 offset:20736
    v_cvt_pk_bf16_f32 v229, v94, v95
    v_mfma_f32_16x16x32_bf16 v[120:123], a[56:59], v[144:147], v[120:123]
    s_waitcnt lgkmcnt(6)
    ds_read_b64_tr_b16 a[76:77], v10 offset:16640
    ds_read_b64_tr_b16 a[78:79], v10 offset:20736
    v_mfma_f32_16x16x32_bf16 v[112:115], a[60:63], v[148:151], v[112:115]
    s_add_u32 m0, s29, 0x1c000
    ds_read_b64_tr_b16 a[80:81], v12 offset:16384
    buffer_load_dwordx4 v2, s[20:23], s35 offen sc1 nt lds
    v_mfma_f32_16x16x32_bf16 v[120:123], a[60:63], v[152:155], v[120:123]
    s_waitcnt lgkmcnt(7)
    ds_read_b64_tr_b16 a[82:83], v12 offset:20480
    ds_read_b64_tr_b16 a[84:85], v13 offset:16384
    v_mfma_f32_16x16x32_bf16 v[156:159], a[64:67], v[68:71], v[156:159]
    v_exp_f32 v100, v100
    v_mfma_f32_16x16x32_bf16 v[188:191], a[64:67], v[72:75], v[188:191]
    s_waitcnt lgkmcnt(7)
    v_exp_f32 v101, v101
    v_mfma_f32_16x16x32_bf16 v[160:163], a[68:71], v[68:71], v[160:163]
    ds_read_b64_tr_b16 a[86:87], v13 offset:20480
    ds_read_b64_tr_b16 a[88:89], v12 offset:16640
    v_mfma_f32_16x16x32_bf16 v[192:195], a[68:71], v[72:75], v[192:195]
    s_waitcnt lgkmcnt(7)
    v_exp_f32 v102, v102
    v_mfma_f32_16x16x32_bf16 v[164:167], a[72:75], v[68:71], v[164:167]
    ds_read_b64_tr_b16 a[90:91], v12 offset:20736
    ds_read_b64_tr_b16 a[92:93], v13 offset:16640
    v_mfma_f32_16x16x32_bf16 v[196:199], a[72:75], v[72:75], v[196:199]
    s_waitcnt lgkmcnt(7)
    buffer_load_dwordx4 v4, s[20:23], s35 offen offset:1024 sc1 nt lds
    v_mfma_f32_16x16x32_bf16 v[168:171], a[76:79], v[68:71], v[168:171]
    ds_read_b64_tr_b16 a[94:95], v13 offset:20736
    ds_read_b64_tr_b16 a[96:97], v9 offset:24576
    v_mfma_f32_16x16x32_bf16 v[200:203], a[76:79], v[72:75], v[200:203]
    s_waitcnt lgkmcnt(7)
    v_exp_f32 v103, v103
    v_mfma_f32_16x16x32_bf16 v[172:175], a[80:83], v[68:71], v[172:175]
    ds_read_b64_tr_b16 a[98:99], v9 offset:28672
    v_cvt_pk_bf16_f32 v232, v100, v101
    v_mfma_f32_16x16x32_bf16 v[204:207], a[80:83], v[72:75], v[204:207]
    s_waitcnt lgkmcnt(6)
    ds_read_b64_tr_b16 a[100:101], v10 offset:24576
    v_cvt_pk_bf16_f32 v233, v102, v103
    v_mfma_f32_16x16x32_bf16 v[176:179], a[84:87], v[68:71], v[176:179]
    ds_read_b64_tr_b16 a[102:103], v10 offset:28672
    ds_read_b64_tr_b16 a[104:105], v9 offset:24832
    v_mfma_f32_16x16x32_bf16 v[208:211], a[84:87], v[72:75], v[208:211]
    s_waitcnt lgkmcnt(7)
    v_exp_f32 v96, v96
    v_mfma_f32_16x16x32_bf16 v[180:183], a[88:91], v[68:71], v[180:183]
    buffer_load_dwordx4 v2, s[20:23], s35 offen offset:2048 sc1 nt lds
    v_mfma_f32_16x16x32_bf16 v[212:215], a[88:91], v[72:75], v[212:215]
    s_waitcnt lgkmcnt(5)
    ds_read_b64_tr_b16 a[106:107], v9 offset:28928
    ds_read_b64_tr_b16 a[108:109], v10 offset:24832
    v_mfma_f32_16x16x32_bf16 v[184:187], a[92:95], v[68:71], v[184:187]
    v_exp_f32 v97, v97
    v_mfma_f32_16x16x32_bf16 v[216:219], a[92:95], v[72:75], v[216:219]
    ds_read_b64_tr_b16 a[110:111], v10 offset:28928
    ds_read_b64_tr_b16 a[112:113], v12 offset:24576
    v_mfma_f32_16x16x32_bf16 v[36:39], v[32:35], v[68:71], v[36:39]
    v_exp_f32 v98, v98
    v_mfma_f32_16x16x32_bf16 v[40:43], v[32:35], v[72:75], v[40:43]
    s_waitcnt lgkmcnt(7)
    ds_read_b64_tr_b16 a[114:115], v12 offset:28672
    ds_read_b64_tr_b16 a[116:117], v13 offset:24576
    v_mfma_f32_16x16x32_bf16 v[156:159], a[96:99], v[220:223], v[156:159]
    v_exp_f32 v99, v99
    v_mfma_f32_16x16x32_bf16 v[188:191], a[96:99], v[224:227], v[188:191]
    s_waitcnt lgkmcnt(7)
    buffer_load_dwordx4 v4, s[20:23], s35 offen offset:3072 sc1 nt lds
    v_mfma_f32_16x16x32_bf16 v[160:163], a[100:103], v[220:223], v[160:163]
    ds_read_b64_tr_b16 a[118:119], v13 offset:28672
    v_cvt_pk_bf16_f32 v230, v96, v97
    v_mfma_f32_16x16x32_bf16 v[192:195], a[100:103], v[224:227], v[192:195]
    s_waitcnt lgkmcnt(6)
    ds_read_b64_tr_b16 a[120:121], v12 offset:24832
    v_cvt_pk_bf16_f32 v231, v98, v99
    v_mfma_f32_16x16x32_bf16 v[164:167], a[104:107], v[220:223], v[164:167]
    ds_read_b64_tr_b16 a[122:123], v12 offset:28928
    ds_read_b64_tr_b16 a[124:125], v13 offset:24832
    v_mfma_f32_16x16x32_bf16 v[196:199], a[104:107], v[224:227], v[196:199]
    s_waitcnt lgkmcnt(7)
    v_exp_f32 v104, v104
    v_mfma_f32_16x16x32_bf16 v[168:171], a[108:111], v[220:223], v[168:171]
    ds_read_b64_tr_b16 a[126:127], v13 offset:28928
    v_exp_f32 v105, v105
    v_mfma_f32_16x16x32_bf16 v[200:203], a[108:111], v[224:227], v[200:203]
    s_waitcnt lgkmcnt(6)
    v_exp_f32 v106, v106
    v_mfma_f32_16x16x32_bf16 v[172:175], a[112:115], v[220:223], v[172:175]
    v_exp_f32 v107, v107
    v_mfma_f32_16x16x32_bf16 v[204:207], a[112:115], v[224:227], v[204:207]
    s_waitcnt vmcnt(12) lgkmcnt(4)
    s_barrier
    v_mfma_f32_16x16x32_bf16 v[176:179], a[116:119], v[220:223], v[176:179]
    ds_read_b128 a[0:3], v8 offset:49152
    v_cvt_pk_bf16_f32 v234, v104, v105
    v_mfma_f32_16x16x32_bf16 v[208:211], a[116:119], v[224:227], v[208:211]
    s_waitcnt lgkmcnt(3)
    ds_read_b128 a[4:7], v8 offset:49408
    v_cvt_pk_bf16_f32 v235, v106, v107
    v_mfma_f32_16x16x32_bf16 v[180:183], a[120:123], v[220:223], v[180:183]
    s_add_u32 m0, s29, 0x4000
    ds_read_b128 a[8:11], v8 offset:49664
    buffer_load_dwordx4 v2, s[16:19], s37 offen sc1 nt lds
    v_mfma_f32_16x16x32_bf16 v[212:215], a[120:123], v[224:227], v[212:215]
    s_waitcnt lgkmcnt(3)
    v_exp_f32 v108, v108
    v_mfma_f32_16x16x32_bf16 v[184:187], a[124:127], v[220:223], v[184:187]
    v_exp_f32 v109, v109
    v_mfma_f32_16x16x32_bf16 v[216:219], a[124:127], v[224:227], v[216:219]
    v_exp_f32 v110, v110
    v_mfma_f32_16x16x32_bf16 v[36:39], v[32:35], v[220:223], v[36:39]
    ds_read_b128 a[12:15], v8 offset:49920
    ds_read_b128 a[16:19], v8 offset:53248
    v_mfma_f32_16x16x32_bf16 v[40:43], v[32:35], v[224:227], v[40:43]
    s_waitcnt lgkmcnt(4)
    v_exp_f32 v111, v111
    v_mfma_f32_16x16x32_bf16 v[76:79], a[0:3], v[124:127], v[44:47]
    ds_read_b128 a[20:23], v8 offset:53504
    v_cvt_pk_bf16_f32 v236, v108, v109
    v_mfma_f32_16x16x32_bf16 v[84:87], a[0:3], v[128:131], v[48:51]
    s_waitcnt lgkmcnt(4)
    buffer_load_dwordx4 v5, s[16:19], s37 offen offset:1024 sc1 nt lds
    v_mfma_f32_16x16x32_bf16 v[76:79], a[4:7], v[132:135], v[76:79]
    ds_read_b128 a[24:27], v8 offset:53760
    v_cvt_pk_bf16_f32 v237, v110, v111
    v_mfma_f32_16x16x32_bf16 v[84:87], a[4:7], v[136:139], v[84:87]
    s_waitcnt lgkmcnt(4)
    v_exp_f32 v116, v116
    v_mfma_f32_16x16x32_bf16 v[76:79], a[8:11], v[140:143], v[76:79]
    v_exp_f32 v117, v117
    v_mfma_f32_16x16x32_bf16 v[84:87], a[8:11], v[144:147], v[84:87]
    s_waitcnt lgkmcnt(3)
    v_exp_f32 v118, v118
    v_mfma_f32_16x16x32_bf16 v[76:79], a[12:15], v[148:151], v[76:79]
    ds_read_b128 a[28:31], v8 offset:54016
    ds_read_b128 a[32:35], v8 offset:57344
    v_mfma_f32_16x16x32_bf16 v[84:87], a[12:15], v[152:155], v[84:87]
    s_waitcnt lgkmcnt(4)
    v_exp_f32 v119, v119
    v_mfma_f32_16x16x32_bf16 v[80:83], a[16:19], v[124:127], v[44:47]
    buffer_load_dwordx4 v4, s[16:19], s37 offen offset:2048 sc1 nt lds
    v_mfma_f32_16x16x32_bf16 v[88:91], a[16:19], v[128:131], v[48:51]
    s_waitcnt lgkmcnt(3)
    ds_read_b128 a[36:39], v8 offset:57600
    v_cvt_pk_bf16_f32 v240, v116, v117
    v_mfma_f32_16x16x32_bf16 v[80:83], a[20:23], v[132:135], v[80:83]
    ds_read_b128 a[40:43], v8 offset:57856
    v_cvt_pk_bf16_f32 v241, v118, v119
    v_mfma_f32_16x16x32_bf16 v[88:91], a[20:23], v[136:139], v[88:91]
    s_waitcnt lgkmcnt(4)
    v_exp_f32 v112, v112
    v_mfma_f32_16x16x32_bf16 v[80:83], a[24:27], v[140:143], v[80:83]
    v_exp_f32 v113, v113
    v_mfma_f32_16x16x32_bf16 v[88:91], a[24:27], v[144:147], v[88:91]
    s_waitcnt lgkmcnt(3)
    v_exp_f32 v114, v114
    v_mfma_f32_16x16x32_bf16 v[80:83], a[28:31], v[148:151], v[80:83]
    ds_read_b128 a[44:47], v8 offset:58112
    ds_read_b128 a[48:51], v8 offset:61440
    v_mfma_f32_16x16x32_bf16 v[88:91], a[28:31], v[152:155], v[88:91]
    s_waitcnt lgkmcnt(4)
    buffer_load_dwordx4 v3, s[16:19], s37 offen offset:3072 sc1 nt lds
    v_mfma_f32_16x16x32_bf16 v[92:95], a[32:35], v[124:127], v[44:47]
    v_exp_f32 v115, v115
    v_mfma_f32_16x16x32_bf16 v[100:103], a[32:35], v[128:131], v[48:51]
    s_waitcnt lgkmcnt(3)
    ds_read_b128 a[52:55], v8 offset:61696
    v_cvt_pk_bf16_f32 v238, v112, v113
    v_mfma_f32_16x16x32_bf16 v[92:95], a[36:39], v[132:135], v[92:95]
    ds_read_b128 a[56:59], v8 offset:61952
    v_cvt_pk_bf16_f32 v239, v114, v115
    v_mfma_f32_16x16x32_bf16 v[100:103], a[36:39], v[136:139], v[100:103]
    s_waitcnt lgkmcnt(4)
    v_exp_f32 v120, v120
    v_mfma_f32_16x16x32_bf16 v[92:95], a[40:43], v[140:143], v[92:95]
    ds_read_b128 a[60:63], v8 offset:62208
    v_exp_f32 v121, v121
    v_mfma_f32_16x16x32_bf16 v[100:103], a[40:43], v[144:147], v[100:103]
    s_waitcnt lgkmcnt(4)
    v_exp_f32 v122, v122
    v_mfma_f32_16x16x32_bf16 v[92:95], a[44:47], v[148:151], v[92:95]
    v_exp_f32 v123, v123
    v_mfma_f32_16x16x32_bf16 v[100:103], a[44:47], v[152:155], v[100:103]
    s_waitcnt vmcnt(12) lgkmcnt(3)
    s_barrier
    v_mfma_f32_16x16x32_bf16 v[96:99], a[48:51], v[124:127], v[44:47]
    ds_read_b64_tr_b16 a[64:65], v9 offset:32768
    ds_read_b64_tr_b16 a[66:67], v9 offset:36864
    v_mfma_f32_16x16x32_bf16 v[104:107], a[48:51], v[128:131], v[48:51]
    s_waitcnt lgkmcnt(4)
    ds_read_b64_tr_b16 a[68:69], v10 offset:32768
    v_cvt_pk_bf16_f32 v242, v120, v121
    v_mfma_f32_16x16x32_bf16 v[96:99], a[52:55], v[132:135], v[96:99]
    ds_read_b64_tr_b16 a[70:71], v10 offset:36864
    v_cvt_pk_bf16_f32 v243, v122, v123
    v_mfma_f32_16x16x32_bf16 v[104:107], a[52:55], v[136:139], v[104:107]
    s_waitcnt lgkmcnt(5)
    ds_read_b64_tr_b16 a[72:73], v9 offset:33024
    ds_read_b64_tr_b16 a[74:75], v9 offset:37120
    v_mfma_f32_16x16x32_bf16 v[96:99], a[56:59], v[140:143], v[96:99]
    s_add_u32 m0, s29, 0x10000
    ds_read_b64_tr_b16 a[76:77], v10 offset:33024
    buffer_load_dwordx4 v2, s[20:23], s36 offen sc1 nt lds
    v_mfma_f32_16x16x32_bf16 v[104:107], a[56:59], v[144:147], v[104:107]
    s_waitcnt lgkmcnt(7)
    ds_read_b64_tr_b16 a[78:79], v10 offset:37120
    ds_read_b64_tr_b16 a[80:81], v12 offset:32768
    v_mfma_f32_16x16x32_bf16 v[96:99], a[60:63], v[148:151], v[96:99]
    v_exp_f32 v76, v76
    v_mfma_f32_16x16x32_bf16 v[104:107], a[60:63], v[152:155], v[104:107]
    s_waitcnt lgkmcnt(7)
    ds_read_b64_tr_b16 a[82:83], v12 offset:36864
    ds_read_b64_tr_b16 a[84:85], v13 offset:32768
    v_mfma_f32_16x16x32_bf16 v[156:159], a[64:67], v[228:231], v[156:159]
    v_exp_f32 v77, v77
    v_mfma_f32_16x16x32_bf16 v[188:191], a[64:67], v[232:235], v[188:191]
    s_waitcnt lgkmcnt(7)
    v_exp_f32 v78, v78
    v_mfma_f32_16x16x32_bf16 v[160:163], a[68:71], v[228:231], v[160:163]
    ds_read_b64_tr_b16 a[86:87], v13 offset:36864
    ds_read_b64_tr_b16 a[88:89], v12 offset:33024
    v_mfma_f32_16x16x32_bf16 v[192:195], a[68:71], v[232:235], v[192:195]
    s_waitcnt lgkmcnt(7)
    buffer_load_dwordx4 v4, s[20:23], s36 offen offset:1024 sc1 nt lds
    v_mfma_f32_16x16x32_bf16 v[164:167], a[72:75], v[228:231], v[164:167]
    ds_read_b64_tr_b16 a[90:91], v12 offset:37120
    ds_read_b64_tr_b16 a[92:93], v13 offset:33024
    v_mfma_f32_16x16x32_bf16 v[196:199], a[72:75], v[232:235], v[196:199]
    s_waitcnt lgkmcnt(7)
    v_exp_f32 v79, v79
    v_mfma_f32_16x16x32_bf16 v[168:171], a[76:79], v[228:231], v[168:171]
    ds_read_b64_tr_b16 a[94:95], v13 offset:37120
    v_cvt_pk_bf16_f32 v244, v76, v77
    v_mfma_f32_16x16x32_bf16 v[200:203], a[76:79], v[232:235], v[200:203]
    s_waitcnt lgkmcnt(6)
    ds_read_b64_tr_b16 a[96:97], v9 offset:40960
    v_cvt_pk_bf16_f32 v245, v78, v79
    v_mfma_f32_16x16x32_bf16 v[172:175], a[80:83], v[228:231], v[172:175]
    ds_read_b64_tr_b16 a[98:99], v9 offset:45056
    ds_read_b64_tr_b16 a[100:101], v10 offset:40960
    v_mfma_f32_16x16x32_bf16 v[204:207], a[80:83], v[232:235], v[204:207]
    s_waitcnt lgkmcnt(7)
    v_exp_f32 v84, v84
    v_mfma_f32_16x16x32_bf16 v[176:179], a[84:87], v[228:231], v[176:179]
    buffer_load_dwordx4 v2, s[20:23], s36 offen offset:2048 sc1 nt lds
    v_mfma_f32_16x16x32_bf16 v[208:211], a[84:87], v[232:235], v[208:211]
    s_waitcnt lgkmcnt(5)
    ds_read_b64_tr_b16 a[102:103], v10 offset:45056
    ds_read_b64_tr_b16 a[104:105], v9 offset:41216
    v_mfma_f32_16x16x32_bf16 v[180:183], a[88:91], v[228:231], v[180:183]
    v_exp_f32 v85, v85
    v_mfma_f32_16x16x32_bf16 v[212:215], a[88:91], v[232:235], v[212:215]
    s_waitcnt lgkmcnt(5)
    ds_read_b64_tr_b16 a[106:107], v9 offset:45312
    ds_read_b64_tr_b16 a[108:109], v10 offset:41216
    v_mfma_f32_16x16x32_bf16 v[184:187], a[92:95], v[228:231], v[184:187]
    v_exp_f32 v86, v86
    v_mfma_f32_16x16x32_bf16 v[216:219], a[92:95], v[232:235], v[216:219]
    ds_read_b64_tr_b16 a[110:111], v10 offset:45312
    ds_read_b64_tr_b16 a[112:113], v12 offset:40960
    v_mfma_f32_16x16x32_bf16 v[36:39], v[32:35], v[228:231], v[36:39]
    v_exp_f32 v87, v87
    v_mfma_f32_16x16x32_bf16 v[40:43], v[32:35], v[232:235], v[40:43]
    s_waitcnt lgkmcnt(7)
    buffer_load_dwordx4 v4, s[20:23], s36 offen offset:3072 sc1 nt lds
    v_mfma_f32_16x16x32_bf16 v[156:159], a[96:99], v[236:239], v[156:159]
    ds_read_b64_tr_b16 a[114:115], v12 offset:45056
    v_cvt_pk_bf16_f32 v248, v84, v85
    v_mfma_f32_16x16x32_bf16 v[188:191], a[96:99], v[240:243], v[188:191]
    s_waitcnt lgkmcnt(6)
    ds_read_b64_tr_b16 a[116:117], v13 offset:40960
    v_cvt_pk_bf16_f32 v249, v86, v87
    v_mfma_f32_16x16x32_bf16 v[160:163], a[100:103], v[236:239], v[160:163]
    ds_read_b64_tr_b16 a[118:119], v13 offset:45056
    ds_read_b64_tr_b16 a[120:121], v12 offset:41216
    v_mfma_f32_16x16x32_bf16 v[192:195], a[100:103], v[240:243], v[192:195]
    s_waitcnt lgkmcnt(7)
    v_exp_f32 v80, v80
    v_mfma_f32_16x16x32_bf16 v[164:167], a[104:107], v[236:239], v[164:167]
    ds_read_b64_tr_b16 a[122:123], v12 offset:45312
    ds_read_b64_tr_b16 a[124:125], v13 offset:41216
    v_mfma_f32_16x16x32_bf16 v[196:199], a[104:107], v[240:243], v[196:199]
    s_waitcnt lgkmcnt(7)
    v_exp_f32 v81, v81
    v_mfma_f32_16x16x32_bf16 v[168:171], a[108:111], v[236:239], v[168:171]
    ds_read_b64_tr_b16 a[126:127], v13 offset:45312
    v_exp_f32 v82, v82
    v_mfma_f32_16x16x32_bf16 v[200:203], a[108:111], v[240:243], v[200:203]
    s_waitcnt lgkmcnt(6)
    v_exp_f32 v83, v83
    v_mfma_f32_16x16x32_bf16 v[172:175], a[112:115], v[236:239], v[172:175]
    v_cvt_pk_bf16_f32 v246, v80, v81
    v_cvt_pk_bf16_f32 v247, v82, v83
    v_mfma_f32_16x16x32_bf16 v[204:207], a[112:115], v[240:243], v[204:207]
    s_waitcnt vmcnt(12) lgkmcnt(4)
    s_barrier
    v_mfma_f32_16x16x32_bf16 v[176:179], a[116:119], v[236:239], v[176:179]
    ds_read_b128 a[0:3], v8
    ds_read_b128 a[4:7], v8 offset:256
    v_mfma_f32_16x16x32_bf16 v[208:211], a[116:119], v[240:243], v[208:211]
    s_waitcnt lgkmcnt(4)
    v_exp_f32 v88, v88
    v_mfma_f32_16x16x32_bf16 v[180:183], a[120:123], v[236:239], v[180:183]
    s_add_u32 m0, s29, 0x8000
    ds_read_b128 a[8:11], v8 offset:512
    buffer_load_dwordx4 v2, s[16:19], s38 offen sc1 nt lds
    v_mfma_f32_16x16x32_bf16 v[212:215], a[120:123], v[240:243], v[212:215]
    s_waitcnt lgkmcnt(3)
    v_exp_f32 v89, v89
    v_mfma_f32_16x16x32_bf16 v[184:187], a[124:127], v[236:239], v[184:187]
    v_exp_f32 v90, v90
    v_mfma_f32_16x16x32_bf16 v[216:219], a[124:127], v[240:243], v[216:219]
    v_exp_f32 v91, v91
    v_mfma_f32_16x16x32_bf16 v[36:39], v[32:35], v[236:239], v[36:39]
    ds_read_b128 a[12:15], v8 offset:768
    v_cvt_pk_bf16_f32 v250, v88, v89
    v_mfma_f32_16x16x32_bf16 v[40:43], v[32:35], v[240:243], v[40:43]
    s_waitcnt lgkmcnt(3)
    ds_read_b128 a[16:19], v8 offset:4096
    v_cvt_pk_bf16_f32 v251, v90, v91
    v_mfma_f32_16x16x32_bf16 v[108:111], a[0:3], v[124:127], v[44:47]
    v_exp_f32 v92, v92
    v_mfma_f32_16x16x32_bf16 v[116:119], a[0:3], v[128:131], v[48:51]
    s_waitcnt lgkmcnt(3)
    buffer_load_dwordx4 v5, s[16:19], s38 offen offset:1024 sc1 nt lds
    v_mfma_f32_16x16x32_bf16 v[108:111], a[4:7], v[132:135], v[108:111]
    ds_read_b128 a[20:23], v8 offset:4352
    ds_read_b128 a[24:27], v8 offset:4608
    v_mfma_f32_16x16x32_bf16 v[116:119], a[4:7], v[136:139], v[116:119]
    s_waitcnt lgkmcnt(4)
    v_exp_f32 v93, v93
    v_mfma_f32_16x16x32_bf16 v[108:111], a[8:11], v[140:143], v[108:111]
    v_exp_f32 v94, v94
    v_mfma_f32_16x16x32_bf16 v[116:119], a[8:11], v[144:147], v[116:119]
    s_waitcnt lgkmcnt(3)
    v_exp_f32 v95, v95
    v_mfma_f32_16x16x32_bf16 v[108:111], a[12:15], v[148:151], v[108:111]
    ds_read_b128 a[28:31], v8 offset:4864
    v_cvt_pk_bf16_f32 v52, v92, v93
    v_mfma_f32_16x16x32_bf16 v[116:119], a[12:15], v[152:155], v[116:119]
    s_waitcnt lgkmcnt(3)
    ds_read_b128 a[32:35], v8 offset:8192
    v_cvt_pk_bf16_f32 v53, v94, v95
    v_mfma_f32_16x16x32_bf16 v[112:115], a[16:19], v[124:127], v[44:47]
    buffer_load_dwordx4 v4, s[16:19], s38 offen offset:2048 sc1 nt lds
    v_mfma_f32_16x16x32_bf16 v[120:123], a[16:19], v[128:131], v[48:51]
    s_waitcnt lgkmcnt(3)
    v_exp_f32 v100, v100
    v_mfma_f32_16x16x32_bf16 v[112:115], a[20:23], v[132:135], v[112:115]
    ds_read_b128 a[36:39], v8 offset:8448
    ds_read_b128 a[40:43], v8 offset:8704
    v_mfma_f32_16x16x32_bf16 v[120:123], a[20:23], v[136:139], v[120:123]
    s_waitcnt lgkmcnt(4)
    v_exp_f32 v101, v101
    v_mfma_f32_16x16x32_bf16 v[112:115], a[24:27], v[140:143], v[112:115]
    v_exp_f32 v102, v102
    v_mfma_f32_16x16x32_bf16 v[120:123], a[24:27], v[144:147], v[120:123]
    s_waitcnt lgkmcnt(3)
    v_exp_f32 v103, v103
    v_mfma_f32_16x16x32_bf16 v[112:115], a[28:31], v[148:151], v[112:115]
    ds_read_b128 a[44:47], v8 offset:8960
    v_cvt_pk_bf16_f32 v56, v100, v101
    v_mfma_f32_16x16x32_bf16 v[120:123], a[28:31], v[152:155], v[120:123]
    s_waitcnt lgkmcnt(3)
    buffer_load_dwordx4 v3, s[16:19], s38 offen offset:3072 sc1 nt lds
    v_mfma_f32_16x16x32_bf16 v[76:79], a[32:35], v[124:127], v[44:47]
    ds_read_b128 a[48:51], v8 offset:12288
    v_cvt_pk_bf16_f32 v57, v102, v103
    v_mfma_f32_16x16x32_bf16 v[84:87], a[32:35], v[128:131], v[48:51]
    s_waitcnt lgkmcnt(3)
    v_exp_f32 v96, v96
    v_mfma_f32_16x16x32_bf16 v[76:79], a[36:39], v[132:135], v[76:79]
    ds_read_b128 a[52:55], v8 offset:12544
    ds_read_b128 a[56:59], v8 offset:12800
    v_mfma_f32_16x16x32_bf16 v[84:87], a[36:39], v[136:139], v[84:87]
    s_waitcnt lgkmcnt(4)
    v_exp_f32 v97, v97
    v_mfma_f32_16x16x32_bf16 v[76:79], a[40:43], v[140:143], v[76:79]
    ds_read_b128 a[60:63], v8 offset:13056
    v_exp_f32 v98, v98
    v_mfma_f32_16x16x32_bf16 v[84:87], a[40:43], v[144:147], v[84:87]
    s_waitcnt lgkmcnt(4)
    v_exp_f32 v99, v99
    v_mfma_f32_16x16x32_bf16 v[76:79], a[44:47], v[148:151], v[76:79]
    v_cvt_pk_bf16_f32 v54, v96, v97
    v_cvt_pk_bf16_f32 v55, v98, v99
    v_mfma_f32_16x16x32_bf16 v[84:87], a[44:47], v[152:155], v[84:87]
    s_waitcnt vmcnt(12) lgkmcnt(3)
    s_barrier
    v_mfma_f32_16x16x32_bf16 v[80:83], a[48:51], v[124:127], v[44:47]
    ds_read_b64_tr_b16 a[64:65], v9 offset:49152
    ds_read_b64_tr_b16 a[66:67], v9 offset:53248
    v_mfma_f32_16x16x32_bf16 v[88:91], a[48:51], v[128:131], v[48:51]
    s_waitcnt lgkmcnt(4)
    v_exp_f32 v104, v104
    v_mfma_f32_16x16x32_bf16 v[80:83], a[52:55], v[132:135], v[80:83]
    ds_read_b64_tr_b16 a[68:69], v10 offset:49152
    ds_read_b64_tr_b16 a[70:71], v10 offset:53248
    v_mfma_f32_16x16x32_bf16 v[88:91], a[52:55], v[136:139], v[88:91]
    s_waitcnt lgkmcnt(5)
    v_exp_f32 v105, v105
    v_mfma_f32_16x16x32_bf16 v[80:83], a[56:59], v[140:143], v[80:83]
    ds_read_b64_tr_b16 a[72:73], v9 offset:49408
    ds_read_b64_tr_b16 a[74:75], v9 offset:53504
    v_mfma_f32_16x16x32_bf16 v[88:91], a[56:59], v[144:147], v[88:91]
    s_waitcnt lgkmcnt(6)
    ds_read_b64_tr_b16 a[76:77], v10 offset:49408
    v_exp_f32 v106, v106
    v_mfma_f32_16x16x32_bf16 v[80:83], a[60:63], v[148:151], v[80:83]
    ds_read_b64_tr_b16 a[78:79], v10 offset:53504
    ds_read_b64_tr_b16 a[80:81], v12 offset:49152
    v_mfma_f32_16x16x32_bf16 v[88:91], a[60:63], v[152:155], v[88:91]
    s_waitcnt lgkmcnt(7)
    v_exp_f32 v107, v107
    v_mfma_f32_16x16x32_bf16 v[156:159], a[64:67], v[244:247], v[156:159]
    ds_read_b64_tr_b16 a[82:83], v12 offset:53248
    v_cvt_pk_bf16_f32 v58, v104, v105
    v_mfma_f32_16x16x32_bf16 v[188:191], a[64:67], v[248:251], v[188:191]
    s_waitcnt lgkmcnt(6)
    ds_read_b64_tr_b16 a[84:85], v13 offset:49152
    v_cvt_pk_bf16_f32 v59, v106, v107
    v_mfma_f32_16x16x32_bf16 v[160:163], a[68:71], v[244:247], v[160:163]
    ds_read_b64_tr_b16 a[86:87], v13 offset:53248
    ds_read_b64_tr_b16 a[88:89], v12 offset:49408
    v_mfma_f32_16x16x32_bf16 v[192:195], a[68:71], v[248:251], v[192:195]
    s_waitcnt lgkmcnt(7)
    v_exp_f32 v108, v108
    v_mfma_f32_16x16x32_bf16 v[164:167], a[72:75], v[244:247], v[164:167]
    ds_read_b64_tr_b16 a[90:91], v12 offset:53504
    ds_read_b64_tr_b16 a[92:93], v13 offset:49408
    v_mfma_f32_16x16x32_bf16 v[196:199], a[72:75], v[248:251], v[196:199]
    s_waitcnt lgkmcnt(7)
    v_exp_f32 v109, v109
    v_mfma_f32_16x16x32_bf16 v[168:171], a[76:79], v[244:247], v[168:171]
    ds_read_b64_tr_b16 a[94:95], v13 offset:53504
    ds_read_b64_tr_b16 a[96:97], v9 offset:57344
    v_mfma_f32_16x16x32_bf16 v[200:203], a[76:79], v[248:251], v[200:203]
    s_waitcnt lgkmcnt(7)
    v_exp_f32 v110, v110
    v_mfma_f32_16x16x32_bf16 v[172:175], a[80:83], v[244:247], v[172:175]
    s_add_u32 m0, s29, 0x14000
    ds_read_b64_tr_b16 a[98:99], v9 offset:61440
    buffer_load_dwordx4 v2, s[20:23], s37 offen sc1 nt lds
    v_mfma_f32_16x16x32_bf16 v[204:207], a[80:83], v[248:251], v[204:207]
    s_waitcnt lgkmcnt(6)
    ds_read_b64_tr_b16 a[100:101], v10 offset:57344
    ds_read_b64_tr_b16 a[102:103], v10 offset:61440
    v_mfma_f32_16x16x32_bf16 v[176:179], a[84:87], v[244:247], v[176:179]
    v_exp_f32 v111, v111
    v_mfma_f32_16x16x32_bf16 v[208:211], a[84:87], v[248:251], v[208:211]
    s_waitcnt lgkmcnt(6)
    ds_read_b64_tr_b16 a[104:105], v9 offset:57600
    v_cvt_pk_bf16_f32 v60, v108, v109
    v_mfma_f32_16x16x32_bf16 v[180:183], a[88:91], v[244:247], v[180:183]
    ds_read_b64_tr_b16 a[106:107], v9 offset:61696
    v_cvt_pk_bf16_f32 v61, v110, v111
    v_mfma_f32_16x16x32_bf16 v[212:215], a[88:91], v[248:251], v[212:215]
    s_waitcnt lgkmcnt(6)
    ds_read_b64_tr_b16 a[108:109], v10 offset:57600
    ds_read_b64_tr_b16 a[110:111], v10 offset:61696
    v_mfma_f32_16x16x32_bf16 v[184:187], a[92:95], v[244:247], v[184:187]
L_stub1:
    s_cbranch_execz L_stubret
    v_exp_f32 v116, v116
    v_mfma_f32_16x16x32_bf16 v[216:219], a[92:95], v[248:251], v[216:219]
    buffer_load_dwordx4 v4, s[20:23], s37 offen offset:1024 sc1 nt lds
    v_mfma_f32_16x16x32_bf16 v[36:39], v[32:35], v[244:247], v[36:39]
    ds_read_b64_tr_b16 a[112:113], v12 offset:57344
    v_exp_f32 v117, v117
    v_mfma_f32_16x16x32_bf16 v[40:43], v[32:35], v[248:251], v[40:43]
    s_waitcnt lgkmcnt(7)
    ds_read_b64_tr_b16 a[114:115], v12 offset:61440
    ds_read_b64_tr_b16 a[116:117], v13 offset:57344
    v_mfma_f32_16x16x32_bf16 v[156:159], a[96:99], v[52:55], v[156:159]
    ds_read_b64_tr_b16 a[118:119], v13 offset:61440
    v_exp_f32 v118, v118
    v_mfma_f32_16x16x32_bf16 v[188:191], a[96:99], v[56:59], v[188:191]
    s_waitcnt lgkmcnt(8)
    v_exp_f32 v119, v119
    v_mfma_f32_16x16x32_bf16 v[160:163], a[100:103], v[52:55], v[160:163]
    ds_read_b64_tr_b16 a[120:121], v12 offset:57600
    v_cvt_pk_bf16_f32 v64, v116, v117
    v_mfma_f32_16x16x32_bf16 v[192:195], a[100:103], v[56:59], v[192:195]
    s_waitcnt lgkmcnt(7)
    ds_read_b64_tr_b16 a[122:123], v12 offset:61696
    v_cvt_pk_bf16_f32 v65, v118, v119
    v_mfma_f32_16x16x32_bf16 v[164:167], a[104:107], v[52:55], v[164:167]
    buffer_load_dwordx4 v2, s[20:23], s37 offen offset:2048 sc1 nt lds
    v_mfma_f32_16x16x32_bf16 v[196:199], a[104:107], v[56:59], v[196:199]
    s_waitcnt lgkmcnt(6)
    ds_read_b64_tr_b16 a[124:125], v13 offset:57600
    v_exp_f32 v112, v112
    v_mfma_f32_16x16x32_bf16 v[168:171], a[108:111], v[52:55], v[168:171]
    ds_read_b64_tr_b16 a[126:127], v13 offset:61696
    v_exp_f32 v113, v113
    v_mfma_f32_16x16x32_bf16 v[200:203], a[108:111], v[56:59], v[200:203]
    s_waitcnt lgkmcnt(6)
    v_exp_f32 v114, v114
    v_mfma_f32_16x16x32_bf16 v[172:175], a[112:115], v[52:55], v[172:175]
    v_exp_f32 v115, v115
    v_mfma_f32_16x16x32_bf16 v[204:207], a[112:115], v[56:59], v[204:207]
    s_waitcnt vmcnt(11) lgkmcnt(4)
    s_barrier
    v_mfma_f32_16x16x32_bf16 v[176:179], a[116:119], v[52:55], v[176:179]
    ds_read_b128 a[0:3], v8 offset:16384
    v_cvt_pk_bf16_f32 v62, v112, v113
    v_mfma_f32_16x16x32_bf16 v[208:211], a[116:119], v[56:59], v[208:211]
    s_waitcnt lgkmcnt(3)
    buffer_load_dwordx4 v4, s[20:23], s37 offen offset:3072 sc1 nt lds
    v_mfma_f32_16x16x32_bf16 v[180:183], a[120:123], v[52:55], v[180:183]
    ds_read_b128 a[4:7], v8 offset:16640
    v_cvt_pk_bf16_f32 v63, v114, v115
    v_mfma_f32_16x16x32_bf16 v[212:215], a[120:123], v[56:59], v[212:215]
    s_waitcnt lgkmcnt(2)
    ds_read_b128 a[8:11], v8 offset:16896
    v_exp_f32 v120, v120
    v_mfma_f32_16x16x32_bf16 v[184:187], a[124:127], v[52:55], v[184:187]
    v_exp_f32 v121, v121
    v_mfma_f32_16x16x32_bf16 v[216:219], a[124:127], v[56:59], v[216:219]
    ds_read_b128 a[12:15], v8 offset:17152
    v_exp_f32 v122, v122
    v_mfma_f32_16x16x32_bf16 v[36:39], v[32:35], v[52:55], v[36:39]
    v_exp_f32 v123, v123
    v_mfma_f32_16x16x32_bf16 v[40:43], v[32:35], v[56:59], v[40:43]
    s_waitcnt lgkmcnt(3)
    ds_read_b128 a[16:19], v8 offset:20480
    v_cvt_pk_bf16_f32 v66, v120, v121
    v_mfma_f32_16x16x32_bf16 v[92:95], a[0:3], v[124:127], v[44:47]
    s_add_u32 m0, s29, 0xc000
    ds_read_b128 a[20:23], v8 offset:20736
    buffer_load_dwordx4 v2, s[16:19], s39 offen sc1 nt lds
    v_mfma_f32_16x16x32_bf16 v[100:103], a[0:3], v[128:131], v[48:51]
    s_waitcnt lgkmcnt(4)
    ds_read_b128 a[24:27], v8 offset:20992
    v_cvt_pk_bf16_f32 v67, v122, v123
    v_mfma_f32_16x16x32_bf16 v[92:95], a[4:7], v[132:135], v[92:95]
    v_exp_f32 v76, v76
    v_mfma_f32_16x16x32_bf16 v[100:103], a[4:7], v[136:139], v[100:103]
    s_waitcnt lgkmcnt(4)
    v_exp_f32 v77, v77
    v_mfma_f32_16x16x32_bf16 v[92:95], a[8:11], v[140:143], v[92:95]
    ds_read_b128 a[28:31], v8 offset:21248
    v_exp_f32 v78, v78
    v_mfma_f32_16x16x32_bf16 v[100:103], a[8:11], v[144:147], v[100:103]
    s_waitcnt lgkmcnt(4)
    v_exp_f32 v79, v79
    v_mfma_f32_16x16x32_bf16 v[92:95], a[12:15], v[148:151], v[92:95]
    ds_read_b128 a[32:35], v8 offset:24576
    v_cvt_pk_bf16_f32 v68, v76, v77
    v_cvt_pk_bf16_f32 v69, v78, v79
    v_mfma_f32_16x16x32_bf16 v[100:103], a[12:15], v[152:155], v[100:103]
    s_waitcnt lgkmcnt(4)
    buffer_load_dwordx4 v5, s[16:19], s39 offen offset:1024 sc1 nt lds
    v_mfma_f32_16x16x32_bf16 v[96:99], a[16:19], v[124:127], v[44:47]
    ds_read_b128 a[36:39], v8 offset:24832
    v_exp_f32 v84, v84
    v_mfma_f32_16x16x32_bf16 v[104:107], a[16:19], v[128:131], v[48:51]
    s_waitcnt lgkmcnt(4)
    v_exp_f32 v85, v85
    v_mfma_f32_16x16x32_bf16 v[96:99], a[20:23], v[132:135], v[96:99]
    ds_read_b128 a[40:43], v8 offset:25088
    v_exp_f32 v86, v86
    v_mfma_f32_16x16x32_bf16 v[104:107], a[20:23], v[136:139], v[104:107]
    s_waitcnt lgkmcnt(4)
    v_exp_f32 v87, v87
    v_mfma_f32_16x16x32_bf16 v[96:99], a[24:27], v[140:143], v[96:99]
    ds_read_b128 a[44:47], v8 offset:25344
    v_cvt_pk_bf16_f32 v72, v84, v85
    v_mfma_f32_16x16x32_bf16 v[104:107], a[24:27], v[144:147], v[104:107]
    s_waitcnt lgkmcnt(4)
    ds_read_b128 a[48:51], v8 offset:28672
    v_cvt_pk_bf16_f32 v73, v86, v87
    v_mfma_f32_16x16x32_bf16 v[96:99], a[28:31], v[148:151], v[96:99]
    buffer_load_dwordx4 v4, s[16:19], s39 offen offset:2048 sc1 nt lds
    v_mfma_f32_16x16x32_bf16 v[104:107], a[28:31], v[152:155], v[104:107]
    s_waitcnt lgkmcnt(4)
    v_exp_f32 v80, v80
    v_exp_f32 v81, v81
    v_mfma_f32_16x16x32_bf16 v[108:111], a[32:35], v[124:127], v[44:47]
    v_exp_f32 v82, v82
    v_mfma_f32_16x16x32_bf16 v[116:119], a[32:35], v[128:131], v[48:51]
    s_waitcnt lgkmcnt(3)
    ds_read_b128 a[52:55], v8 offset:28928
    v_exp_f32 v83, v83
    v_mfma_f32_16x16x32_bf16 v[108:111], a[36:39], v[132:135], v[108:111]
    ds_read_b128 a[56:59], v8 offset:29184
    v_cvt_pk_bf16_f32 v70, v80, v81
    v_mfma_f32_16x16x32_bf16 v[116:119], a[36:39], v[136:139], v[116:119]
    s_waitcnt lgkmcnt(4)
    ds_read_b128 a[60:63], v8 offset:29440
    v_cvt_pk_bf16_f32 v71, v82, v83
    v_mfma_f32_16x16x32_bf16 v[108:111], a[40:43], v[140:143], v[108:111]
    v_exp_f32 v88, v88
    v_mfma_f32_16x16x32_bf16 v[116:119], a[40:43], v[144:147], v[116:119]
    s_waitcnt lgkmcnt(4)
    buffer_load_dwordx4 v3, s[16:19], s39 offen offset:3072 sc1 nt lds
    v_mfma_f32_16x16x32_bf16 v[108:111], a[44:47], v[148:151], v[108:111]
    v_exp_f32 v89, v89
    v_exp_f32 v90, v90
    v_mfma_f32_16x16x32_bf16 v[116:119], a[44:47], v[152:155], v[116:119]
    s_waitcnt vmcnt(12) lgkmcnt(3)
    s_barrier
    v_mfma_f32_16x16x32_bf16 v[112:115], a[48:51], v[124:127], v[44:47]
    ds_read_b64_tr_b16 a[64:65], v9
    ds_read_b64_tr_b16 a[66:67], v9 offset:4096
    v_mfma_f32_16x16x32_bf16 v[120:123], a[48:51], v[128:131], v[48:51]
    s_waitcnt lgkmcnt(4)
    ds_read_b64_tr_b16 a[68:69], v10
    v_exp_f32 v91, v91
    v_mfma_f32_16x16x32_bf16 v[112:115], a[52:55], v[132:135], v[112:115]
    ds_read_b64_tr_b16 a[70:71], v10 offset:4096
    v_cvt_pk_bf16_f32 v74, v88, v89
    v_cvt_pk_bf16_f32 v75, v90, v91
    v_mfma_f32_16x16x32_bf16 v[120:123], a[52:55], v[136:139], v[120:123]
    s_waitcnt lgkmcnt(5)
    ds_read_b64_tr_b16 a[72:73], v9 offset:256
    ds_read_b64_tr_b16 a[74:75], v9 offset:4352
    v_mfma_f32_16x16x32_bf16 v[112:115], a[56:59], v[140:143], v[112:115]
    s_add_u32 m0, s29, 0x18000
    ds_read_b64_tr_b16 a[76:77], v10 offset:256
    buffer_load_dwordx4 v2, s[20:23], s38 offen sc1 nt lds
    v_mfma_f32_16x16x32_bf16 v[120:123], a[56:59], v[144:147], v[120:123]
    s_waitcnt lgkmcnt(7)
    v_exp_f32 v92, v92
    v_mfma_f32_16x16x32_bf16 v[112:115], a[60:63], v[148:151], v[112:115]
    ds_read_b64_tr_b16 a[78:79], v10 offset:4352
    ds_read_b64_tr_b16 a[96:97], v9 offset:8192
    v_mfma_f32_16x16x32_bf16 v[120:123], a[60:63], v[152:155], v[120:123]
    s_waitcnt lgkmcnt(7)
    ds_read_b64_tr_b16 a[98:99], v9 offset:12288
    v_exp_f32 v93, v93
    v_mfma_f32_16x16x32_bf16 v[156:159], a[64:67], v[60:63], v[156:159]
    ds_read_b64_tr_b16 a[100:101], v10 offset:8192
    v_exp_f32 v94, v94
    v_mfma_f32_16x16x32_bf16 v[188:191], a[64:67], v[64:67], v[188:191]
    s_waitcnt lgkmcnt(7)
    v_exp_f32 v95, v95
    v_mfma_f32_16x16x32_bf16 v[160:163], a[68:71], v[60:63], v[160:163]
    ds_read_b64_tr_b16 a[102:103], v10 offset:12288
    v_cvt_pk_bf16_f32 v220, v92, v93
    v_cvt_pk_bf16_f32 v221, v94, v95
    v_mfma_f32_16x16x32_bf16 v[192:195], a[68:71], v[64:67], v[192:195]
    s_waitcnt lgkmcnt(6)
    buffer_load_dwordx4 v4, s[20:23], s38 offen offset:1024 sc1 nt lds
    v_mfma_f32_16x16x32_bf16 v[164:167], a[72:75], v[60:63], v[164:167]
    ds_read_b64_tr_b16 a[104:105], v9 offset:8448
    v_exp_f32 v100, v100
    v_mfma_f32_16x16x32_bf16 v[196:199], a[72:75], v[64:67], v[196:199]
    s_waitcnt lgkmcnt(5)
    v_exp_f32 v101, v101
    v_mfma_f32_16x16x32_bf16 v[168:171], a[76:79], v[60:63], v[168:171]
    ds_read_b64_tr_b16 a[106:107], v9 offset:12544
    v_exp_f32 v102, v102
    v_mfma_f32_16x16x32_bf16 v[200:203], a[76:79], v[64:67], v[200:203]
    v_exp_f32 v103, v103
    v_mfma_f32_16x16x32_bf16 v[36:39], v[32:35], v[60:63], v[36:39]
    ds_read_b64_tr_b16 a[108:109], v10 offset:8448
    ds_read_b64_tr_b16 a[110:111], v10 offset:12544
    v_cvt_pk_bf16_f32 v224, v100, v101
    v_mfma_f32_16x16x32_bf16 v[40:43], v[32:35], v[64:67], v[40:43]
    s_waitcnt lgkmcnt(6)
    v_cvt_pk_bf16_f32 v225, v102, v103
    v_exp_f32 v96, v96
    v_mfma_f32_16x16x32_bf16 v[156:159], a[96:99], v[68:71], v[156:159]
    buffer_load_dwordx4 v2, s[20:23], s38 offen offset:2048 sc1 nt lds
    v_mfma_f32_16x16x32_bf16 v[188:191], a[96:99], v[72:75], v[188:191]
    s_waitcnt vmcnt(11) lgkmcnt(4)
    s_barrier
    v_mfma_f32_16x16x32_bf16 v[160:163], a[100:103], v[68:71], v[160:163]
    ds_read_b128 a[0:3], v8 offset:32768
    v_exp_f32 v97, v97
    v_mfma_f32_16x16x32_bf16 v[192:195], a[100:103], v[72:75], v[192:195]
    s_waitcnt lgkmcnt(3)
    ds_read_b128 a[4:7], v8 offset:33024
    v_exp_f32 v98, v98
    v_mfma_f32_16x16x32_bf16 v[164:167], a[104:107], v[68:71], v[164:167]
    ds_read_b128 a[8:11], v8 offset:33280
    ds_read_b128 a[12:15], v8 offset:33536
    v_mfma_f32_16x16x32_bf16 v[196:199], a[104:107], v[72:75], v[196:199]
    s_waitcnt lgkmcnt(4)
    ds_read_b128 a[16:19], v8 offset:36864
    v_exp_f32 v99, v99
    v_mfma_f32_16x16x32_bf16 v[168:171], a[108:111], v[68:71], v[168:171]
    ds_read_b64_tr_b16 a[128:129], v12
    v_cvt_pk_bf16_f32 v222, v96, v97
    v_mfma_f32_16x16x32_bf16 v[200:203], a[108:111], v[72:75], v[200:203]
    buffer_load_dwordx4 v4, s[20:23], s38 offen offset:3072 sc1 nt lds
    v_cvt_pk_bf16_f32 v223, v98, v99
    v_mfma_f32_16x16x32_bf16 v[36:39], v[32:35], v[68:71], v[36:39]
    ds_read_b128 a[20:23], v8 offset:37120
    ds_read_b64_tr_b16 a[130:131], v12 offset:4096
    v_mfma_f32_16x16x32_bf16 v[40:43], v[32:35], v[72:75], v[40:43]
    s_waitcnt lgkmcnt(7)
    ds_read_b128 a[24:27], v8 offset:37376
    v_exp_f32 v104, v104
    v_mfma_f32_16x16x32_bf16 v[76:79], a[0:3], v[124:127], v[44:47]
    v_exp_f32 v105, v105
    v_mfma_f32_16x16x32_bf16 v[84:87], a[0:3], v[128:131], v[48:51]
    s_waitcnt lgkmcnt(7)
    ds_read_b64_tr_b16 a[132:133], v13
    v_exp_f32 v106, v106
    v_mfma_f32_16x16x32_bf16 v[76:79], a[4:7], v[132:135], v[76:79]
    ds_read_b128 a[28:31], v8 offset:37632
    ds_read_b64_tr_b16 a[134:135], v13 offset:4096
    v_mfma_f32_16x16x32_bf16 v[84:87], a[4:7], v[136:139], v[84:87]
    s_waitcnt lgkmcnt(9)
    ds_read_b128 a[32:35], v8 offset:40960
    v_exp_f32 v107, v107
    v_mfma_f32_16x16x32_bf16 v[76:79], a[8:11], v[140:143], v[76:79]
    s_add_u32 m0, s29, 0x1c000
    ds_read_b64_tr_b16 a[136:137], v12 offset:256
    buffer_load_dwordx4 v2, s[20:23], s39 offen sc1 nt lds
    v_mfma_f32_16x16x32_bf16 v[84:87], a[8:11], v[144:147], v[84:87]
    s_waitcnt lgkmcnt(10)
    ds_read_b128 a[36:39], v8 offset:41216
    v_cvt_pk_bf16_f32 v226, v104, v105
    v_mfma_f32_16x16x32_bf16 v[76:79], a[12:15], v[148:151], v[76:79]
    ds_read_b64_tr_b16 a[138:139], v12 offset:4352
    v_cvt_pk_bf16_f32 v227, v106, v107
    v_mfma_f32_16x16x32_bf16 v[84:87], a[12:15], v[152:155], v[84:87]
    s_waitcnt lgkmcnt(11)
    ds_read_b64_tr_b16 a[144:145], v12 offset:8192
    ds_read_b128 a[40:43], v8 offset:41472
    v_exp_f32 v108, v108
    v_mfma_f32_16x16x32_bf16 v[80:83], a[16:19], v[124:127], v[44:47]
    v_exp_f32 v109, v109
    v_mfma_f32_16x16x32_bf16 v[88:91], a[16:19], v[128:131], v[48:51]
    s_waitcnt lgkmcnt(11)
    ds_read_b64_tr_b16 a[140:141], v13 offset:256
    v_exp_f32 v110, v110
    v_mfma_f32_16x16x32_bf16 v[80:83], a[20:23], v[132:135], v[80:83]
    ds_read_b64_tr_b16 a[146:147], v12 offset:12288
    v_exp_f32 v111, v111
    v_mfma_f32_16x16x32_bf16 v[88:91], a[20:23], v[136:139], v[88:91]
    s_waitcnt lgkmcnt(11)
    buffer_load_dwordx4 v4, s[20:23], s39 offen offset:1024 sc1 nt lds
    v_mfma_f32_16x16x32_bf16 v[80:83], a[24:27], v[140:143], v[80:83]
    ds_read_b128 a[44:47], v8 offset:41728
    v_cvt_pk_bf16_f32 v228, v108, v109
    v_cvt_pk_bf16_f32 v229, v110, v111
    v_mfma_f32_16x16x32_bf16 v[88:91], a[24:27], v[144:147], v[88:91]
    s_waitcnt lgkmcnt(10)
    ds_read_b64_tr_b16 a[142:143], v13 offset:4352
    v_exp_f32 v116, v116
    v_mfma_f32_16x16x32_bf16 v[80:83], a[28:31], v[148:151], v[80:83]
    ds_read_b64_tr_b16 a[148:149], v13 offset:8192
    v_exp_f32 v117, v117
    v_mfma_f32_16x16x32_bf16 v[88:91], a[28:31], v[152:155], v[88:91]
    s_waitcnt lgkmcnt(10)
    ds_read_b128 a[48:51], v8 offset:45056
    ds_read_b64_tr_b16 a[150:151], v13 offset:12288
    v_mfma_f32_16x16x32_bf16 v[92:95], a[32:35], v[124:127], v[44:47]
    ds_read_b128 a[52:55], v8 offset:45312
    v_exp_f32 v118, v118
    v_mfma_f32_16x16x32_bf16 v[100:103], a[32:35], v[128:131], v[48:51]
    s_waitcnt lgkmcnt(11)
    ds_read_b64_tr_b16 a[152:153], v12 offset:8448
    v_exp_f32 v119, v119
    v_mfma_f32_16x16x32_bf16 v[92:95], a[36:39], v[132:135], v[92:95]
    buffer_load_dwordx4 v2, s[20:23], s39 offen offset:2048 sc1 nt lds
    v_cvt_pk_bf16_f32 v232, v116, v117
    v_mfma_f32_16x16x32_bf16 v[100:103], a[36:39], v[136:139], v[100:103]
    s_waitcnt lgkmcnt(9)
    ds_read_b128 a[56:59], v8 offset:45568
    v_cvt_pk_bf16_f32 v233, v118, v119
    v_mfma_f32_16x16x32_bf16 v[92:95], a[40:43], v[140:143], v[92:95]
    ds_read_b64_tr_b16 a[154:155], v12 offset:12544
    ds_read_b128 a[60:63], v8 offset:45824
    v_exp_f32 v112, v112
    v_mfma_f32_16x16x32_bf16 v[100:103], a[40:43], v[144:147], v[100:103]
    s_waitcnt lgkmcnt(9)
    ds_read_b64_tr_b16 a[156:157], v13 offset:8448
    v_exp_f32 v113, v113
    v_mfma_f32_16x16x32_bf16 v[92:95], a[44:47], v[148:151], v[92:95]
    ds_read_b64_tr_b16 a[158:159], v13 offset:12544
    v_exp_f32 v114, v114
    v_mfma_f32_16x16x32_bf16 v[100:103], a[44:47], v[152:155], v[100:103]
    s_waitcnt vmcnt(11) lgkmcnt(8)
    s_barrier
    v_mfma_f32_16x16x32_bf16 v[96:99], a[48:51], v[124:127], v[44:47]
    ds_read_b64_tr_b16 a[64:65], v9 offset:16384
    ds_read_b64_tr_b16 a[66:67], v9 offset:20480
    v_exp_f32 v115, v115
    v_mfma_f32_16x16x32_bf16 v[104:107], a[48:51], v[128:131], v[48:51]
    s_waitcnt lgkmcnt(8)
    buffer_load_dwordx4 v4, s[20:23], s39 offen offset:3072 sc1 nt lds
    v_cvt_pk_bf16_f32 v230, v112, v113
    v_mfma_f32_16x16x32_bf16 v[96:99], a[52:55], v[132:135], v[96:99]
    ds_read_b64_tr_b16 a[68:69], v10 offset:16384
    ds_read_b64_tr_b16 a[70:71], v10 offset:20480
    v_cvt_pk_bf16_f32 v231, v114, v115
    v_mfma_f32_16x16x32_bf16 v[104:107], a[52:55], v[136:139], v[104:107]
    s_waitcnt lgkmcnt(8)
    ds_read_b64_tr_b16 a[72:73], v9 offset:16640
    v_exp_f32 v120, v120
    v_mfma_f32_16x16x32_bf16 v[96:99], a[56:59], v[140:143], v[96:99]
    ds_read_b64_tr_b16 a[74:75], v9 offset:20736
    v_exp_f32 v121, v121
    v_mfma_f32_16x16x32_bf16 v[104:107], a[56:59], v[144:147], v[104:107]
    s_waitcnt lgkmcnt(8)
    ds_read_b64_tr_b16 a[76:77], v10 offset:16640
    v_exp_f32 v122, v122
    v_mfma_f32_16x16x32_bf16 v[96:99], a[60:63], v[148:151], v[96:99]
    ds_read_b64_tr_b16 a[78:79], v10 offset:20736
    v_exp_f32 v123, v123
    v_mfma_f32_16x16x32_bf16 v[104:107], a[60:63], v[152:155], v[104:107]
    s_waitcnt lgkmcnt(6)
    ds_read_b64_tr_b16 a[96:97], v9 offset:24576
    v_cvt_pk_bf16_f32 v234, v120, v121
    v_cvt_pk_bf16_f32 v235, v122, v123
    v_mfma_f32_16x16x32_bf16 v[156:159], a[64:67], v[220:223], v[156:159]
    ds_read_b64_tr_b16 a[98:99], v9 offset:28672
    v_exp_f32 v76, v76
    v_mfma_f32_16x16x32_bf16 v[188:191], a[64:67], v[224:227], v[188:191]
    s_waitcnt lgkmcnt(6)
    ds_read_b64_tr_b16 a[100:101], v10 offset:24576
    v_exp_f32 v77, v77
    v_mfma_f32_16x16x32_bf16 v[160:163], a[68:71], v[220:223], v[160:163]
    ds_read_b64_tr_b16 a[102:103], v10 offset:28672
    v_exp_f32 v78, v78
    v_mfma_f32_16x16x32_bf16 v[192:195], a[68:71], v[224:227], v[192:195]
    s_waitcnt lgkmcnt(6)
    ds_read_b64_tr_b16 a[104:105], v9 offset:24832
    v_exp_f32 v79, v79
    v_mfma_f32_16x16x32_bf16 v[164:167], a[72:75], v[220:223], v[164:167]
    ds_read_b64_tr_b16 a[106:107], v9 offset:28928
    v_cvt_pk_bf16_f32 v236, v76, v77
    v_cvt_pk_bf16_f32 v237, v78, v79
    v_mfma_f32_16x16x32_bf16 v[196:199], a[72:75], v[224:227], v[196:199]
    s_waitcnt lgkmcnt(6)
    ds_read_b64_tr_b16 a[108:109], v10 offset:24832
    v_exp_f32 v84, v84
    v_mfma_f32_16x16x32_bf16 v[168:171], a[76:79], v[220:223], v[168:171]
    v_exp_f32 v85, v85
    v_mfma_f32_16x16x32_bf16 v[200:203], a[76:79], v[224:227], v[200:203]
    ds_read_b64_tr_b16 a[110:111], v10 offset:28928
    v_exp_f32 v86, v86
    v_mfma_f32_16x16x32_bf16 v[36:39], v[32:35], v[220:223], v[36:39]
    v_exp_f32 v87, v87
    v_cvt_pk_bf16_f32 v240, v84, v85
    v_mfma_f32_16x16x32_bf16 v[40:43], v[32:35], v[224:227], v[40:43]
    s_waitcnt lgkmcnt(6)
    v_cvt_pk_bf16_f32 v241, v86, v87
    v_exp_f32 v80, v80
    v_mfma_f32_16x16x32_bf16 v[156:159], a[96:99], v[228:231], v[156:159]
    v_exp_f32 v81, v81
    v_mfma_f32_16x16x32_bf16 v[188:191], a[96:99], v[232:235], v[188:191]
    s_waitcnt vmcnt(8) lgkmcnt(4)
    s_barrier
    v_exp_f32 v82, v82
    v_mfma_f32_16x16x32_bf16 v[160:163], a[100:103], v[228:231], v[160:163]
    ds_read_b128 a[0:3], v8 offset:49152
    v_exp_f32 v83, v83
    v_mfma_f32_16x16x32_bf16 v[192:195], a[100:103], v[232:235], v[192:195]
    s_waitcnt lgkmcnt(3)
    ds_read_b128 a[4:7], v8 offset:49408
    v_cvt_pk_bf16_f32 v238, v80, v81
    v_cvt_pk_bf16_f32 v239, v82, v83
    v_mfma_f32_16x16x32_bf16 v[164:167], a[104:107], v[228:231], v[164:167]
    ds_read_b128 a[8:11], v8 offset:49664
    v_exp_f32 v88, v88
    v_mfma_f32_16x16x32_bf16 v[196:199], a[104:107], v[232:235], v[196:199]
    s_waitcnt lgkmcnt(3)
    ds_read_b128 a[12:15], v8 offset:49920
    v_exp_f32 v89, v89
    v_mfma_f32_16x16x32_bf16 v[168:171], a[108:111], v[228:231], v[168:171]
    ds_read_b128 a[16:19], v8 offset:53248
    v_exp_f32 v90, v90
    v_mfma_f32_16x16x32_bf16 v[200:203], a[108:111], v[232:235], v[200:203]
    ds_read_b64_tr_b16 a[160:161], v12 offset:16384
    v_exp_f32 v91, v91
    v_mfma_f32_16x16x32_bf16 v[36:39], v[32:35], v[228:231], v[36:39]
    ds_read_b128 a[20:23], v8 offset:53504
    v_cvt_pk_bf16_f32 v242, v88, v89
    v_cvt_pk_bf16_f32 v243, v90, v91
    v_mfma_f32_16x16x32_bf16 v[40:43], v[32:35], v[232:235], v[40:43]
    s_waitcnt lgkmcnt(6)
    ds_read_b64_tr_b16 a[162:163], v12 offset:20480
    v_exp_f32 v92, v92
    v_mfma_f32_16x16x32_bf16 v[108:111], a[0:3], v[124:127], v[44:47]
    ds_read_b128 a[24:27], v8 offset:53760
    v_exp_f32 v93, v93
    v_mfma_f32_16x16x32_bf16 v[116:119], a[0:3], v[128:131], v[48:51]
    s_waitcnt lgkmcnt(7)
    v_exp_f32 v94, v94
    v_mfma_f32_16x16x32_bf16 v[108:111], a[4:7], v[132:135], v[108:111]
    ds_read_b64_tr_b16 a[164:165], v13 offset:16384
    v_exp_f32 v95, v95
    v_mfma_f32_16x16x32_bf16 v[116:119], a[4:7], v[136:139], v[116:119]
    s_waitcnt lgkmcnt(7)
    ds_read_b128 a[28:31], v8 offset:54016
    v_cvt_pk_bf16_f32 v244, v92, v93
    v_cvt_pk_bf16_f32 v245, v94, v95
    v_mfma_f32_16x16x32_bf16 v[108:111], a[8:11], v[140:143], v[108:111]
    ds_read_b64_tr_b16 a[166:167], v13 offset:20480
    v_exp_f32 v100, v100
    v_mfma_f32_16x16x32_bf16 v[116:119], a[8:11], v[144:147], v[116:119]
    s_waitcnt lgkmcnt(8)
    ds_read_b128 a[32:35], v8 offset:57344
    v_exp_f32 v101, v101
    v_mfma_f32_16x16x32_bf16 v[108:111], a[12:15], v[148:151], v[108:111]
    ds_read_b64_tr_b16 a[168:169], v12 offset:16640
    v_exp_f32 v102, v102
    v_mfma_f32_16x16x32_bf16 v[116:119], a[12:15], v[152:155], v[116:119]
    s_waitcnt lgkmcnt(9)
    ds_read_b128 a[36:39], v8 offset:57600
    v_exp_f32 v103, v103
    v_mfma_f32_16x16x32_bf16 v[112:115], a[16:19], v[124:127], v[44:47]
    ds_read_b64_tr_b16 a[170:171], v12 offset:20736
    v_cvt_pk_bf16_f32 v248, v100, v101
    v_cvt_pk_bf16_f32 v249, v102, v103
    v_mfma_f32_16x16x32_bf16 v[120:123], a[16:19], v[128:131], v[48:51]
    s_waitcnt lgkmcnt(9)
    ds_read_b64_tr_b16 a[176:177], v12 offset:24576
    v_exp_f32 v96, v96
    v_mfma_f32_16x16x32_bf16 v[112:115], a[20:23], v[132:135], v[112:115]
    ds_read_b128 a[40:43], v8 offset:57856
    v_exp_f32 v97, v97
    v_mfma_f32_16x16x32_bf16 v[120:123], a[20:23], v[136:139], v[120:123]
    s_waitcnt lgkmcnt(9)
    ds_read_b64_tr_b16 a[172:173], v13 offset:16640
    v_exp_f32 v98, v98
    v_mfma_f32_16x16x32_bf16 v[112:115], a[24:27], v[140:143], v[112:115]
    ds_read_b64_tr_b16 a[178:179], v12 offset:28672
    v_exp_f32 v99, v99
    v_mfma_f32_16x16x32_bf16 v[120:123], a[24:27], v[144:147], v[120:123]
    s_waitcnt lgkmcnt(9)
    ds_read_b128 a[44:47], v8 offset:58112
    v_cvt_pk_bf16_f32 v246, v96, v97
    v_cvt_pk_bf16_f32 v247, v98, v99
    v_mfma_f32_16x16x32_bf16 v[112:115], a[28:31], v[148:151], v[112:115]
    ds_read_b64_tr_b16 a[174:175], v13 offset:20736
    ds_read_b64_tr_b16 a[180:181], v13 offset:24576
    v_mfma_f32_16x16x32_bf16 v[120:123], a[28:31], v[152:155], v[120:123]
    s_waitcnt lgkmcnt(10)
    v_exp_f32 v104, v104
    v_exp_f32 v105, v105
    v_mfma_f32_16x16x32_bf16 v[76:79], a[32:35], v[124:127], v[44:47]
    ds_read_b128 a[48:51], v8 offset:61440
    ds_read_b64_tr_b16 a[182:183], v13 offset:28672
    v_mfma_f32_16x16x32_bf16 v[84:87], a[32:35], v[128:131], v[48:51]
    s_waitcnt lgkmcnt(10)
    ds_read_b128 a[52:55], v8 offset:61696
    v_exp_f32 v106, v106
    v_mfma_f32_16x16x32_bf16 v[76:79], a[36:39], v[132:135], v[76:79]
    ds_read_b64_tr_b16 a[184:185], v12 offset:24832
    v_exp_f32 v107, v107
    v_mfma_f32_16x16x32_bf16 v[84:87], a[36:39], v[136:139], v[84:87]
    s_waitcnt lgkmcnt(9)
    ds_read_b128 a[56:59], v8 offset:61952
    v_cvt_pk_bf16_f32 v250, v104, v105
    v_cvt_pk_bf16_f32 v251, v106, v107
    v_mfma_f32_16x16x32_bf16 v[76:79], a[40:43], v[140:143], v[76:79]
    ds_read_b64_tr_b16 a[186:187], v12 offset:28928
    v_exp_f32 v108, v108
    v_mfma_f32_16x16x32_bf16 v[84:87], a[40:43], v[144:147], v[84:87]
    s_waitcnt lgkmcnt(8)
    ds_read_b128 a[60:63], v8 offset:62208
    v_exp_f32 v109, v109
    v_mfma_f32_16x16x32_bf16 v[76:79], a[44:47], v[148:151], v[76:79]
    ds_read_b64_tr_b16 a[188:189], v13 offset:24832
    v_exp_f32 v110, v110
    v_mfma_f32_16x16x32_bf16 v[84:87], a[44:47], v[152:155], v[84:87]
    s_waitcnt vmcnt(4) lgkmcnt(7)
    s_barrier
    v_mfma_f32_16x16x32_bf16 v[80:83], a[48:51], v[124:127], v[44:47]
    ds_read_b64_tr_b16 a[190:191], v13 offset:28928
    ds_read_b64_tr_b16 a[64:65], v9 offset:32768
    ds_read_b64_tr_b16 a[66:67], v9 offset:36864
    v_mfma_f32_16x16x32_bf16 v[88:91], a[48:51], v[128:131], v[48:51]
    s_waitcnt lgkmcnt(8)
    v_exp_f32 v111, v111
    v_cvt_pk_bf16_f32 v92, v108, v109
    v_cvt_pk_bf16_f32 v93, v110, v111
    v_mfma_f32_16x16x32_bf16 v[80:83], a[52:55], v[132:135], v[80:83]
    ds_read_b64_tr_b16 a[68:69], v10 offset:32768
    ds_read_b64_tr_b16 a[70:71], v10 offset:36864
    v_mfma_f32_16x16x32_bf16 v[88:91], a[52:55], v[136:139], v[88:91]
    s_waitcnt lgkmcnt(8)
    v_exp_f32 v116, v116
    v_exp_f32 v117, v117
    v_mfma_f32_16x16x32_bf16 v[80:83], a[56:59], v[140:143], v[80:83]
    ds_read_b64_tr_b16 a[72:73], v9 offset:33024
    ds_read_b64_tr_b16 a[74:75], v9 offset:37120
    v_mfma_f32_16x16x32_bf16 v[88:91], a[56:59], v[144:147], v[88:91]
    s_waitcnt lgkmcnt(8)
    v_exp_f32 v118, v118
    v_exp_f32 v119, v119
    v_mfma_f32_16x16x32_bf16 v[80:83], a[60:63], v[148:151], v[80:83]
    ds_read_b64_tr_b16 a[76:77], v10 offset:33024
    ds_read_b64_tr_b16 a[78:79], v10 offset:37120
    v_cvt_pk_bf16_f32 v96, v116, v117
    v_mfma_f32_16x16x32_bf16 v[88:91], a[60:63], v[152:155], v[88:91]
    s_waitcnt lgkmcnt(6)
    ds_read_b64_tr_b16 a[96:97], v9 offset:40960
    v_cvt_pk_bf16_f32 v97, v118, v119
    v_mfma_f32_16x16x32_bf16 v[156:159], a[64:67], v[236:239], v[156:159]
    ds_read_b64_tr_b16 a[98:99], v9 offset:45056
    ds_read_b64_tr_b16 a[100:101], v10 offset:40960
    v_exp_f32 v112, v112
    v_mfma_f32_16x16x32_bf16 v[188:191], a[64:67], v[240:243], v[188:191]
    s_waitcnt lgkmcnt(7)
    ds_read_b64_tr_b16 a[102:103], v10 offset:45056
    v_exp_f32 v113, v113
    v_mfma_f32_16x16x32_bf16 v[160:163], a[68:71], v[236:239], v[160:163]
    v_exp_f32 v114, v114
    v_mfma_f32_16x16x32_bf16 v[192:195], a[68:71], v[240:243], v[192:195]
    s_waitcnt lgkmcnt(6)
    ds_read_b64_tr_b16 a[104:105], v9 offset:41216
    v_exp_f32 v115, v115
    v_mfma_f32_16x16x32_bf16 v[164:167], a[72:75], v[236:239], v[164:167]
    ds_read_b64_tr_b16 a[106:107], v9 offset:45312
    v_cvt_pk_bf16_f32 v94, v112, v113
    v_cvt_pk_bf16_f32 v95, v114, v115
    v_mfma_f32_16x16x32_bf16 v[196:199], a[72:75], v[240:243], v[196:199]
    s_waitcnt lgkmcnt(6)
    ds_read_b64_tr_b16 a[108:109], v10 offset:41216
    v_exp_f32 v120, v120
    v_mfma_f32_16x16x32_bf16 v[168:171], a[76:79], v[236:239], v[168:171]
    ds_read_b64_tr_b16 a[110:111], v10 offset:45312
    v_exp_f32 v121, v121
    v_mfma_f32_16x16x32_bf16 v[200:203], a[76:79], v[240:243], v[200:203]
    v_exp_f32 v122, v122
    v_mfma_f32_16x16x32_bf16 v[36:39], v[32:35], v[236:239], v[36:39]
    v_exp_f32 v123, v123
    v_cvt_pk_bf16_f32 v98, v120, v121
    v_cvt_pk_bf16_f32 v99, v122, v123
    v_mfma_f32_16x16x32_bf16 v[40:43], v[32:35], v[240:243], v[40:43]
    s_waitcnt lgkmcnt(6)
    v_exp_f32 v76, v76
    v_mfma_f32_16x16x32_bf16 v[156:159], a[96:99], v[244:247], v[156:159]
    v_exp_f32 v77, v77
    v_exp_f32 v78, v78
    v_mfma_f32_16x16x32_bf16 v[188:191], a[96:99], v[248:251], v[188:191]
    s_waitcnt vmcnt(0) lgkmcnt(4)
    s_barrier
    v_mfma_f32_16x16x32_bf16 v[160:163], a[100:103], v[244:247], v[160:163]
    ds_read_b64_tr_b16 a[64:65], v9 offset:49152
    ds_read_b64_tr_b16 a[66:67], v9 offset:53248
    v_exp_f32 v79, v79
    v_mfma_f32_16x16x32_bf16 v[192:195], a[100:103], v[248:251], v[192:195]
    s_waitcnt lgkmcnt(4)
    ds_read_b64_tr_b16 a[68:69], v10 offset:49152
    v_cvt_pk_bf16_f32 v100, v76, v77
    v_cvt_pk_bf16_f32 v101, v78, v79
    v_mfma_f32_16x16x32_bf16 v[164:167], a[104:107], v[244:247], v[164:167]
    ds_read_b64_tr_b16 a[70:71], v10 offset:53248
    v_exp_f32 v84, v84
    v_mfma_f32_16x16x32_bf16 v[196:199], a[104:107], v[248:251], v[196:199]
    s_waitcnt lgkmcnt(4)
    ds_read_b64_tr_b16 a[72:73], v9 offset:49408
    v_exp_f32 v85, v85
    v_mfma_f32_16x16x32_bf16 v[168:171], a[108:111], v[244:247], v[168:171]
    ds_read_b64_tr_b16 a[74:75], v9 offset:53504
    v_exp_f32 v86, v86
    v_mfma_f32_16x16x32_bf16 v[200:203], a[108:111], v[248:251], v[200:203]
    ds_read_b64_tr_b16 a[76:77], v10 offset:49408
    v_exp_f32 v87, v87
    v_mfma_f32_16x16x32_bf16 v[36:39], v[32:35], v[244:247], v[36:39]
    ds_read_b64_tr_b16 a[78:79], v10 offset:53504
    v_cvt_pk_bf16_f32 v104, v84, v85
    v_cvt_pk_bf16_f32 v105, v86, v87
    v_mfma_f32_16x16x32_bf16 v[40:43], v[32:35], v[248:251], v[40:43]
    s_waitcnt lgkmcnt(6)
    ds_read_b64_tr_b16 a[192:193], v12 offset:32768
    v_exp_f32 v80, v80
    v_mfma_f32_16x16x32_bf16 v[156:159], a[64:67], v[92:95], v[156:159]
    ds_read_b64_tr_b16 a[194:195], v12 offset:36864
    v_exp_f32 v81, v81
    v_mfma_f32_16x16x32_bf16 v[188:191], a[64:67], v[96:99], v[188:191]
    s_waitcnt lgkmcnt(6)
    ds_read_b64_tr_b16 a[196:197], v13 offset:32768
    v_exp_f32 v82, v82
    v_mfma_f32_16x16x32_bf16 v[160:163], a[68:71], v[92:95], v[160:163]
    ds_read_b64_tr_b16 a[96:97], v9 offset:57344
    v_exp_f32 v83, v83
    v_mfma_f32_16x16x32_bf16 v[192:195], a[68:71], v[96:99], v[192:195]
    s_waitcnt lgkmcnt(6)
    ds_read_b64_tr_b16 a[98:99], v9 offset:61440
    v_cvt_pk_bf16_f32 v102, v80, v81
    v_cvt_pk_bf16_f32 v103, v82, v83
    v_mfma_f32_16x16x32_bf16 v[164:167], a[72:75], v[92:95], v[164:167]
L_stub2:
    s_cbranch_execz L_stubret
    ds_read_b64_tr_b16 a[198:199], v13 offset:36864
    v_exp_f32 v88, v88
    v_mfma_f32_16x16x32_bf16 v[196:199], a[72:75], v[96:99], v[196:199]
    s_waitcnt lgkmcnt(6)
    ds_read_b64_tr_b16 a[100:101], v10 offset:57344
    v_exp_f32 v89, v89
    v_mfma_f32_16x16x32_bf16 v[168:171], a[76:79], v[92:95], v[168:171]
    ds_read_b64_tr_b16 a[102:103], v10 offset:61440
    ds_read_b64_tr_b16 a[200:201], v12 offset:33024
    v_mfma_f32_16x16x32_bf16 v[200:203], a[76:79], v[96:99], v[200:203]
    ds_read_b64_tr_b16 a[104:105], v9 offset:57600
    v_exp_f32 v90, v90
    v_mfma_f32_16x16x32_bf16 v[36:39], v[32:35], v[92:95], v[36:39]
    ds_read_b64_tr_b16 a[106:107], v9 offset:61696
    ds_read_b64_tr_b16 a[202:203], v12 offset:37120
    v_exp_f32 v91, v91
    v_mfma_f32_16x16x32_bf16 v[40:43], v[32:35], v[96:99], v[40:43]
    ds_read_b64_tr_b16 a[208:209], v12 offset:40960
    v_cvt_pk_bf16_f32 v106, v88, v89
    v_cvt_pk_bf16_f32 v107, v90, v91
    v_mfma_f32_16x16x32_bf16 v[36:39], v[32:35], v[100:103], v[36:39]
    ds_read_b64_tr_b16 a[108:109], v10 offset:57600
    ds_read_b64_tr_b16 a[110:111], v10 offset:61696
    v_mfma_f32_16x16x32_bf16 v[40:43], v[32:35], v[104:107], v[40:43]
    s_waitcnt lgkmcnt(10)
    ds_read_b64_tr_b16 a[204:205], v13 offset:33024
    ds_read_b64_tr_b16 a[210:211], v12 offset:45056
    v_mfma_f32_16x16x32_bf16 v[156:159], a[96:99], v[100:103], v[156:159]
    ds_read_b64_tr_b16 a[206:207], v13 offset:37120
    ds_read_b64_tr_b16 a[212:213], v13 offset:40960
    v_mfma_f32_16x16x32_bf16 v[188:191], a[96:99], v[104:107], v[188:191]
    s_waitcnt lgkmcnt(11)
    ds_read_b64_tr_b16 a[214:215], v13 offset:45056
    ds_read_b64_tr_b16 a[216:217], v12 offset:41216
    v_mfma_f32_16x16x32_bf16 v[160:163], a[100:103], v[100:103], v[160:163]
    ds_read_b64_tr_b16 a[218:219], v12 offset:45312
    ds_read_b64_tr_b16 a[224:225], v12 offset:49152
    v_mfma_f32_16x16x32_bf16 v[192:195], a[100:103], v[104:107], v[192:195]
    s_waitcnt lgkmcnt(12)
    ds_read_b64_tr_b16 a[220:221], v13 offset:41216
    ds_read_b64_tr_b16 a[226:227], v12 offset:53248
    v_mfma_f32_16x16x32_bf16 v[164:167], a[104:107], v[100:103], v[164:167]
    ds_read_b64_tr_b16 a[222:223], v13 offset:45312
    ds_read_b64_tr_b16 a[228:229], v13 offset:49152
    v_mfma_f32_16x16x32_bf16 v[196:199], a[104:107], v[104:107], v[196:199]
    s_waitcnt lgkmcnt(12)
    ds_read_b64_tr_b16 a[230:231], v13 offset:53248
    ds_read_b64_tr_b16 a[240:241], v12 offset:57344
    v_mfma_f32_16x16x32_bf16 v[168:171], a[108:111], v[100:103], v[168:171]
    ds_read_b64_tr_b16 a[242:243], v12 offset:61440
    ds_read_b64_tr_b16 a[244:245], v13 offset:57344
    v_mfma_f32_16x16x32_bf16 v[200:203], a[108:111], v[104:107], v[200:203]
    ds_read_b64_tr_b16 a[246:247], v13 offset:61440
    ds_read_b64_tr_b16 a[232:233], v12 offset:49408
    v_mfma_f32_16x16x32_bf16 v[172:175], a[128:131], v[60:63], v[172:175]
    ds_read_b64_tr_b16 a[234:235], v12 offset:53504
    ds_read_b64_tr_b16 a[236:237], v13 offset:49408
    v_mfma_f32_16x16x32_bf16 v[176:179], a[132:135], v[60:63], v[176:179]
    ds_read_b64_tr_b16 a[238:239], v13 offset:53504
    ds_read_b64_tr_b16 a[248:249], v12 offset:57600
    v_mfma_f32_16x16x32_bf16 v[172:175], a[144:147], v[68:71], v[172:175]
    ds_read_b64_tr_b16 a[250:251], v12 offset:61696
    ds_read_b64_tr_b16 a[252:253], v13 offset:57600
    v_mfma_f32_16x16x32_bf16 v[176:179], a[148:151], v[68:71], v[176:179]
    ds_read_b64_tr_b16 a[254:255], v13 offset:61696
    v_rcp_f32 v14, v36
    v_mfma_f32_16x16x32_bf16 v[172:175], a[160:163], v[220:223], v[172:175]
    v_rcp_f32 v15, v40
    v_mfma_f32_16x16x32_bf16 v[176:179], a[164:167], v[220:223], v[176:179]
    v_add_f32 v16, v36, v40
    v_cmp_nle_f32 vcc, v16, v23
    v_mfma_f32_16x16x32_bf16 v[172:175], a[176:179], v[228:231], v[172:175]
    s_cbranch_vccnz L_fallback
    v_mul_f32 v156, v14, v156
    v_mfma_f32_16x16x32_bf16 v[176:179], a[180:183], v[228:231], v[176:179]
    v_mul_f32 v157, v14, v157
    v_mul_f32 v158, v14, v158
    v_mfma_f32_16x16x32_bf16 v[172:175], a[192:195], v[236:239], v[172:175]
    v_mul_f32 v159, v14, v159
    v_mul_f32 v160, v14, v160
    v_mfma_f32_16x16x32_bf16 v[176:179], a[196:199], v[236:239], v[176:179]
    s_waitcnt lgkmcnt(14)
    v_mul_f32 v161, v14, v161
    v_mul_f32 v162, v14, v162
    v_mfma_f32_16x16x32_bf16 v[172:175], a[208:211], v[244:247], v[172:175]
    s_waitcnt lgkmcnt(14)
    v_mul_f32 v163, v14, v163
    v_cvt_pk_bf16_f32 v156, v156, v157
    v_mfma_f32_16x16x32_bf16 v[176:179], a[212:215], v[244:247], v[176:179]
    s_waitcnt lgkmcnt(14)
    v_cvt_pk_bf16_f32 v157, v158, v159
    v_cvt_pk_bf16_f32 v158, v160, v161
    v_mfma_f32_16x16x32_bf16 v[172:175], a[224:227], v[92:95], v[172:175]
    s_waitcnt lgkmcnt(12)
    v_cvt_pk_bf16_f32 v159, v162, v163
    v_mul_f32 v164, v14, v164
    v_mfma_f32_16x16x32_bf16 v[176:179], a[228:231], v[92:95], v[176:179]
    s_waitcnt lgkmcnt(10)
    ds_write2_b64 v20, v[156:157], v[158:159] offset0:0 offset1:4
    v_mul_f32 v165, v14, v165
    v_mfma_f32_16x16x32_bf16 v[172:175], a[240:243], v[100:103], v[172:175]
    s_waitcnt lgkmcnt(9)
    v_mul_f32 v166, v14, v166
    v_mul_f32 v167, v14, v167
    v_mfma_f32_16x16x32_bf16 v[176:179], a[244:247], v[100:103], v[176:179]
    v_mul_f32 v168, v14, v168
    v_mul_f32 v169, v14, v169
    v_mfma_f32_16x16x32_bf16 v[180:183], a[136:139], v[60:63], v[180:183]
    v_mul_f32 v170, v14, v170
    v_mul_f32 v171, v14, v171
    v_mfma_f32_16x16x32_bf16 v[184:187], a[140:143], v[60:63], v[184:187]
    v_cvt_pk_bf16_f32 v164, v164, v165
    v_cvt_pk_bf16_f32 v165, v166, v167
    v_mfma_f32_16x16x32_bf16 v[180:183], a[152:155], v[68:71], v[180:183]
    v_cvt_pk_bf16_f32 v166, v168, v169
    v_cvt_pk_bf16_f32 v167, v170, v171
    v_mfma_f32_16x16x32_bf16 v[184:187], a[156:159], v[68:71], v[184:187]
    ds_write2_b64 v20, v[164:165], v[166:167] offset0:8 offset1:12
    ds_read_b128 v[124:127], v21
    v_mfma_f32_16x16x32_bf16 v[180:183], a[168:171], v[220:223], v[180:183]
    ds_read_b128 v[128:131], v21 offset:1152
    v_mul_f32 v188, v15, v188
    v_mfma_f32_16x16x32_bf16 v[184:187], a[172:175], v[220:223], v[184:187]
    v_mul_f32 v189, v15, v189
    v_mul_f32 v190, v15, v190
    v_mfma_f32_16x16x32_bf16 v[180:183], a[184:187], v[228:231], v[180:183]
    v_mul_f32 v191, v15, v191
    v_mul_f32 v192, v15, v192
    v_mfma_f32_16x16x32_bf16 v[184:187], a[188:191], v[228:231], v[184:187]
    v_mul_f32 v193, v15, v193
    v_mul_f32 v194, v15, v194
    v_mfma_f32_16x16x32_bf16 v[180:183], a[200:203], v[236:239], v[180:183]
    v_mul_f32 v195, v15, v195
    v_cvt_pk_bf16_f32 v188, v188, v189
    v_mfma_f32_16x16x32_bf16 v[184:187], a[204:207], v[236:239], v[184:187]
    v_cvt_pk_bf16_f32 v189, v190, v191
    v_cvt_pk_bf16_f32 v190, v192, v193
    v_mfma_f32_16x16x32_bf16 v[180:183], a[216:219], v[244:247], v[180:183]
    v_cvt_pk_bf16_f32 v191, v194, v195
    v_mul_f32 v196, v15, v196
    v_mfma_f32_16x16x32_bf16 v[184:187], a[220:223], v[244:247], v[184:187]
    s_waitcnt lgkmcnt(10)
    ds_write2_b64 v11, v[188:189], v[190:191] offset0:0 offset1:4
    v_mul_f32 v197, v15, v197
    v_mfma_f32_16x16x32_bf16 v[180:183], a[232:235], v[92:95], v[180:183]
    s_waitcnt lgkmcnt(9)
    s_waitcnt lgkmcnt(2)
    buffer_store_dwordx4 v[124:127], v22, s[24:27], 0 offen sc1 nt
    v_mfma_f32_16x16x32_bf16 v[184:187], a[236:239], v[92:95], v[184:187]
    s_waitcnt lgkmcnt(7)
    v_mul_f32 v198, v15, v198
    v_mul_f32 v199, v15, v199
    v_mfma_f32_16x16x32_bf16 v[180:183], a[248:251], v[100:103], v[180:183]
    s_waitcnt lgkmcnt(5)
    v_mul_f32 v200, v15, v200
    v_mul_f32 v201, v15, v201
    v_mfma_f32_16x16x32_bf16 v[184:187], a[252:255], v[100:103], v[184:187]
    s_waitcnt lgkmcnt(1)
    buffer_store_dwordx4 v[128:131], v22, s[24:27], 0 offen offset:2048 sc1 nt
    v_mfma_f32_16x16x32_bf16 v[204:207], a[128:131], v[64:67], v[204:207]
    v_mul_f32 v202, v15, v202
    v_mul_f32 v203, v15, v203
    v_mfma_f32_16x16x32_bf16 v[208:211], a[132:135], v[64:67], v[208:211]
    v_cvt_pk_bf16_f32 v196, v196, v197
    v_cvt_pk_bf16_f32 v197, v198, v199
    v_mfma_f32_16x16x32_bf16 v[204:207], a[144:147], v[72:75], v[204:207]
    v_cvt_pk_bf16_f32 v198, v200, v201
    v_cvt_pk_bf16_f32 v199, v202, v203
    v_mfma_f32_16x16x32_bf16 v[208:211], a[148:151], v[72:75], v[208:211]
    ds_write2_b64 v11, v[196:197], v[198:199] offset0:8 offset1:12
    ds_read_b128 v[132:135], v21 offset:2304
    v_mfma_f32_16x16x32_bf16 v[204:207], a[160:163], v[224:227], v[204:207]
    ds_read_b128 v[136:139], v21 offset:3456
    v_mul_f32 v172, v14, v172
    v_mfma_f32_16x16x32_bf16 v[208:211], a[164:167], v[224:227], v[208:211]
    v_mul_f32 v173, v14, v173
    v_mul_f32 v174, v14, v174
    v_mfma_f32_16x16x32_bf16 v[204:207], a[176:179], v[232:235], v[204:207]
    v_mul_f32 v175, v14, v175
    v_mul_f32 v176, v14, v176
    v_mfma_f32_16x16x32_bf16 v[208:211], a[180:183], v[232:235], v[208:211]
    v_mul_f32 v177, v14, v177
    v_mul_f32 v178, v14, v178
    v_mfma_f32_16x16x32_bf16 v[204:207], a[192:195], v[240:243], v[204:207]
    v_mul_f32 v179, v14, v179
    v_cvt_pk_bf16_f32 v172, v172, v173
    v_mfma_f32_16x16x32_bf16 v[208:211], a[196:199], v[240:243], v[208:211]
    v_cvt_pk_bf16_f32 v173, v174, v175
    v_cvt_pk_bf16_f32 v174, v176, v177
    v_mfma_f32_16x16x32_bf16 v[204:207], a[208:211], v[248:251], v[204:207]
    v_cvt_pk_bf16_f32 v175, v178, v179
    v_mul_f32 v180, v14, v180
    v_mfma_f32_16x16x32_bf16 v[208:211], a[212:215], v[248:251], v[208:211]
    ds_write2_b64 v30, v[172:173], v[174:175] offset0:0 offset1:4
    v_mul_f32 v181, v14, v181
    v_mfma_f32_16x16x32_bf16 v[204:207], a[224:227], v[96:99], v[204:207]
    s_waitcnt lgkmcnt(2)
    buffer_store_dwordx4 v[132:135], v22, s[24:27], s43 offen sc1 nt
    v_mfma_f32_16x16x32_bf16 v[208:211], a[228:231], v[96:99], v[208:211]
    v_mul_f32 v182, v14, v182
    v_mul_f32 v183, v14, v183
    v_mfma_f32_16x16x32_bf16 v[204:207], a[240:243], v[104:107], v[204:207]
    v_mul_f32 v184, v14, v184
    v_mul_f32 v185, v14, v185
    v_mfma_f32_16x16x32_bf16 v[208:211], a[244:247], v[104:107], v[208:211]
    s_waitcnt lgkmcnt(1)
    buffer_store_dwordx4 v[136:139], v22, s[24:27], s43 offen offset:2048 sc1 nt
    v_mfma_f32_16x16x32_bf16 v[212:215], a[136:139], v[64:67], v[212:215]
    v_mul_f32 v186, v14, v186
    v_mul_f32 v187, v14, v187
    v_mfma_f32_16x16x32_bf16 v[216:219], a[140:143], v[64:67], v[216:219]
    v_cvt_pk_bf16_f32 v180, v180, v181
    v_cvt_pk_bf16_f32 v181, v182, v183
    v_mfma_f32_16x16x32_bf16 v[212:215], a[152:155], v[72:75], v[212:215]
    v_cvt_pk_bf16_f32 v182, v184, v185
    v_cvt_pk_bf16_f32 v183, v186, v187
    v_mfma_f32_16x16x32_bf16 v[216:219], a[156:159], v[72:75], v[216:219]
    ds_write2_b64 v30, v[180:181], v[182:183] offset0:8 offset1:12
    ds_read_b128 v[140:143], v21 offset:4608
    v_mfma_f32_16x16x32_bf16 v[212:215], a[168:171], v[224:227], v[212:215]
    ds_read_b128 v[144:147], v21 offset:5760
    v_mul_f32 v204, v15, v204
    v_mfma_f32_16x16x32_bf16 v[216:219], a[172:175], v[224:227], v[216:219]
    v_mul_f32 v205, v15, v205
    v_mul_f32 v206, v15, v206
    v_mfma_f32_16x16x32_bf16 v[212:215], a[184:187], v[232:235], v[212:215]
    v_mul_f32 v207, v15, v207
    v_mul_f32 v208, v15, v208
    v_mfma_f32_16x16x32_bf16 v[216:219], a[188:191], v[232:235], v[216:219]
    v_mul_f32 v209, v15, v209
    v_mul_f32 v210, v15, v210
    v_mfma_f32_16x16x32_bf16 v[212:215], a[200:203], v[240:243], v[212:215]
    v_mul_f32 v211, v15, v211
    v_cvt_pk_bf16_f32 v204, v204, v205
    v_mfma_f32_16x16x32_bf16 v[216:219], a[204:207], v[240:243], v[216:219]
    v_cvt_pk_bf16_f32 v205, v206, v207
    v_cvt_pk_bf16_f32 v206, v208, v209
    v_mfma_f32_16x16x32_bf16 v[212:215], a[216:219], v[248:251], v[212:215]
    v_cvt_pk_bf16_f32 v207, v210, v211
    v_mfma_f32_16x16x32_bf16 v[216:219], a[220:223], v[248:251], v[216:219]
    ds_write2_b64 v31, v[204:205], v[206:207] offset0:0 offset1:4
    v_mfma_f32_16x16x32_bf16 v[212:215], a[232:235], v[96:99], v[212:215]
    s_waitcnt lgkmcnt(2)
    buffer_store_dwordx4 v[140:143], v26, s[24:27], 0 offen sc1 nt
    v_mfma_f32_16x16x32_bf16 v[216:219], a[236:239], v[96:99], v[216:219]
    v_mfma_f32_16x16x32_bf16 v[212:215], a[248:251], v[104:107], v[212:215]
    v_mfma_f32_16x16x32_bf16 v[216:219], a[252:255], v[104:107], v[216:219]
    s_waitcnt lgkmcnt(1)
    buffer_store_dwordx4 v[144:147], v26, s[24:27], 0 offen offset:2048 sc1 nt
L_fin2:
    s_nop 4
    v_pk_mul_f32 v[212:213], v[212:213], v[14:15] op_sel:[0,1]
    v_pk_mul_f32 v[214:215], v[214:215], v[14:15] op_sel:[0,1]
    v_pk_mul_f32 v[216:217], v[216:217], v[14:15] op_sel:[0,1]
    v_pk_mul_f32 v[218:219], v[218:219], v[14:15] op_sel:[0,1]
    v_cvt_pk_bf16_f32 v212, v212, v213
    v_cvt_pk_bf16_f32 v213, v214, v215
    v_cvt_pk_bf16_f32 v214, v216, v217
    v_cvt_pk_bf16_f32 v215, v218, v219
    ds_write2_b64 v31, v[212:213], v[214:215] offset0:8 offset1:12
    ds_read_b128 v[148:151], v21 offset:6912
    ds_read_b128 v[152:155], v21 offset:8064
    s_waitcnt lgkmcnt(1)
    buffer_store_dwordx4 v[148:151], v26, s[24:27], s43 offen sc1 nt
    s_waitcnt lgkmcnt(0)
    buffer_store_dwordx4 v[152:155], v26, s[24:27], s43 offen offset:2048 sc1 nt
L_end:
    s_endpgm
L_hot_end:
L_fallback:
    s_waitcnt vmcnt(0) lgkmcnt(0)
    s_barrier
    s_nop 15
    s_lshl_b32 s43, s28, 14
    s_lshl_b32 s31, s28, 14
    v_add_u32 v8, s43, v8
    v_add_u32 v9, s43, v9
    v_add_u32 v10, s43, v10
    v_add_u32 v8, 0x10000, v8
    s_add_u32 s43, s43, 0x10000
    v_mov_b32 v24, 0xff800000
    v_add_u32 v12, s31, v12
    v_mov_b32 v25, 0xff800000
    v_add_u32 v13, s31, v13
    v_mov_b32 v36, 0
    v_mov_b32 v37, 0
    v_mov_b32 v38, 0
    v_mov_b32 v39, 0
    v_mov_b32 v40, 0
    v_mov_b32 v41, 0
    v_mov_b32 v42, 0
    v_mov_b32 v43, 0
    v_mov_b32 v156, 0
    v_mov_b32 v157, 0
    v_mov_b32 v158, 0
    v_mov_b32 v159, 0
    v_mov_b32 v160, 0
    v_mov_b32 v161, 0
    v_mov_b32 v162, 0
    v_mov_b32 v163, 0
    v_mov_b32 v164, 0
    v_mov_b32 v165, 0
    v_mov_b32 v166, 0
    v_mov_b32 v167, 0
    v_mov_b32 v168, 0
    v_mov_b32 v169, 0
    v_mov_b32 v170, 0
    v_mov_b32 v171, 0
    v_mov_b32 v172, 0
    v_mov_b32 v173, 0
    v_mov_b32 v174, 0
    v_mov_b32 v175, 0
    v_mov_b32 v176, 0
    v_mov_b32 v177, 0
    v_mov_b32 v178, 0
    v_mov_b32 v179, 0
    v_mov_b32 v180, 0
    v_mov_b32 v181, 0
    v_mov_b32 v182, 0
    v_mov_b32 v183, 0
    v_mov_b32 v184, 0
    v_mov_b32 v185, 0
    v_mov_b32 v186, 0
    v_mov_b32 v187, 0
    v_mov_b32 v188, 0
    v_mov_b32 v189, 0
    v_mov_b32 v190, 0
    v_mov_b32 v191, 0
    v_mov_b32 v192, 0
    v_mov_b32 v193, 0
    v_mov_b32 v194, 0
    v_mov_b32 v195, 0
    v_mov_b32 v196, 0
    v_mov_b32 v197, 0
    v_mov_b32 v198, 0
    v_mov_b32 v199, 0
    v_mov_b32 v200, 0
    v_mov_b32 v201, 0
    v_mov_b32 v202, 0
    v_mov_b32 v203, 0
    v_mov_b32 v204, 0
    v_mov_b32 v205, 0
    v_mov_b32 v206, 0
    v_mov_b32 v207, 0
    v_mov_b32 v208, 0
    v_mov_b32 v209, 0
    v_mov_b32 v210, 0
    v_mov_b32 v211, 0
    v_mov_b32 v212, 0
    v_mov_b32 v213, 0
    v_mov_b32 v214, 0
    v_mov_b32 v215, 0
    v_mov_b32 v216, 0
    v_mov_b32 v217, 0
    v_mov_b32 v218, 0
    v_mov_b32 v219, 0
    s_mov_b32 s42, 0
    s_mov_b32 s40, 1.0
L_fb_loop:
    s_add_u32 m0, s43, 0
    s_add_u32 s31, s42, 0
    buffer_load_dwordx4 v2, s[16:19], s31 offen lds
    buffer_load_dwordx4 v5, s[16:19], s31 offen offset:1024 lds
    buffer_load_dwordx4 v4, s[16:19], s31 offen offset:2048 lds
    buffer_load_dwordx4 v3, s[16:19], s31 offen offset:3072 lds
    s_add_u32 m0, s43, 4096
    s_add_u32 s31, s42, 4096
    buffer_load_dwordx4 v2, s[16:19], s31 offen lds
    buffer_load_dwordx4 v5, s[16:19], s31 offen offset:1024 lds
    buffer_load_dwordx4 v4, s[16:19], s31 offen offset:2048 lds
    buffer_load_dwordx4 v3, s[16:19], s31 offen offset:3072 lds
    s_add_u32 m0, s43, 8192
    s_add_u32 s31, s42, 0
    buffer_load_dwordx4 v2, s[20:23], s31 offen lds
    buffer_load_dwordx4 v4, s[20:23], s31 offen offset:1024 lds
    buffer_load_dwordx4 v2, s[20:23], s31 offen offset:2048 lds
    buffer_load_dwordx4 v4, s[20:23], s31 offen offset:3072 lds
    s_add_u32 m0, s43, 12288
    s_add_u32 s31, s42, 4096
    buffer_load_dwordx4 v2, s[20:23], s31 offen lds
    buffer_load_dwordx4 v4, s[20:23], s31 offen offset:1024 lds
    buffer_load_dwordx4 v2, s[20:23], s31 offen offset:2048 lds
    buffer_load_dwordx4 v4, s[20:23], s31 offen offset:3072 lds
    s_waitcnt vmcnt(0)
    ds_read_b128 a[0:3], v8
    ds_read_b128 a[4:7], v8 offset:256
    ds_read_b128 a[8:11], v8 offset:512
    ds_read_b128 a[12:15], v8 offset:768
    ds_read_b128 a[16:19], v8 offset:4096
    ds_read_b128 a[20:23], v8 offset:4352
    ds_read_b128 a[24:27], v8 offset:4608
    ds_read_b128 a[28:31], v8 offset:4864
    ds_read_b64_tr_b16 a[64:65], v9 offset:8192
    ds_read_b64_tr_b16 a[66:67], v9 offset:12288
    ds_read_b64_tr_b16 a[68:69], v10 offset:8192
    ds_read_b64_tr_b16 a[70:71], v10 offset:12288
    ds_read_b64_tr_b16 a[72:73], v9 offset:8448
    ds_read_b64_tr_b16 a[74:75], v9 offset:12544
    ds_read_b64_tr_b16 a[76:77], v10 offset:8448
    ds_read_b64_tr_b16 a[78:79], v10 offset:12544
    ds_read_b64_tr_b16 a[80:81], v12 offset:8192
    ds_read_b64_tr_b16 a[82:83], v12 offset:12288
    ds_read_b64_tr_b16 a[84:85], v13 offset:8192
    ds_read_b64_tr_b16 a[86:87], v13 offset:12288
    ds_read_b64_tr_b16 a[88:89], v12 offset:8448
    ds_read_b64_tr_b16 a[90:91], v12 offset:12544
    ds_read_b64_tr_b16 a[92:93], v13 offset:8448
    ds_read_b64_tr_b16 a[94:95], v13 offset:12544
    s_waitcnt lgkmcnt(14)
    v_mfma_f32_16x16x32_bf16 v[76:79], a[0:3], v[124:127], 0
    v_mfma_f32_16x16x32_bf16 v[84:87], a[0:3], v[128:131], 0
    s_waitcnt lgkmcnt(14)
    v_mfma_f32_16x16x32_bf16 v[76:79], a[4:7], v[132:135], v[76:79]
    v_mfma_f32_16x16x32_bf16 v[84:87], a[4:7], v[136:139], v[84:87]
    s_waitcnt lgkmcnt(14)
    v_mfma_f32_16x16x32_bf16 v[76:79], a[8:11], v[140:143], v[76:79]
    v_mfma_f32_16x16x32_bf16 v[84:87], a[8:11], v[144:147], v[84:87]
    s_waitcnt lgkmcnt(14)
    v_mfma_f32_16x16x32_bf16 v[76:79], a[12:15], v[148:151], v[76:79]
    v_mfma_f32_16x16x32_bf16 v[84:87], a[12:15], v[152:155], v[84:87]
    s_waitcnt lgkmcnt(14)
    v_mfma_f32_16x16x32_bf16 v[80:83], a[16:19], v[124:127], 0
    v_mfma_f32_16x16x32_bf16 v[88:91], a[16:19], v[128:131], 0
    s_waitcnt lgkmcnt(14)
    v_mfma_f32_16x16x32_bf16 v[80:83], a[20:23], v[132:135], v[80:83]
    v_mfma_f32_16x16x32_bf16 v[88:91], a[20:23], v[136:139], v[88:91]
    s_waitcnt lgkmcnt(14)
    v_mfma_f32_16x16x32_bf16 v[80:83], a[24:27], v[140:143], v[80:83]
    v_mfma_f32_16x16x32_bf16 v[88:91], a[24:27], v[144:147], v[88:91]
    s_waitcnt lgkmcnt(14)
    v_mfma_f32_16x16x32_bf16 v[80:83], a[28:31], v[148:151], v[80:83]
    v_mfma_f32_16x16x32_bf16 v[88:91], a[28:31], v[152:155], v[88:91]
    v_max3_f32 v16, v76, v77, v78
    s_nop 5
    v_max3_f32 v16, v16, v79, v80
    v_max3_f32 v16, v16, v81, v82
    v_max3_f32 v16, v16, v83, v24
    v_max3_f32 v17, v84, v85, v86
    v_max3_f32 v17, v17, v87, v88
    v_max3_f32 v17, v17, v89, v90
    v_max3_f32 v17, v17, v91, v25
    s_nop 1
    v_permlane32_swap_b32 v16, v17
    v_max_f32 v16, v16, v17
    v_mov_b32 v18, v16
    s_nop 1
    v_permlane16_swap_b32 v16, v18
    v_max_f32 v16, v16, v18
    v_mov_b32 v17, v16
    s_nop 1
    v_permlane32_swap_b32 v16, v17
    v_sub_f32 v18, v24, v16
    v_mul_f32 v18, s40, v18
    v_exp_f32 v18, v18
    v_mov_b32 v24, v16
    v_mul_f32_e64 v28, -v16, s40
    v_sub_f32 v19, v25, v17
    v_mul_f32 v19, s40, v19
    v_exp_f32 v19, v19
    v_mov_b32 v25, v17
    v_mul_f32_e64 v29, -v17, s40
    v_fma_f32 v76, v76, s40, v28
    v_fma_f32 v77, v77, s40, v28
    v_fma_f32 v78, v78, s40, v28
    v_fma_f32 v79, v79, s40, v28
    v_fma_f32 v80, v80, s40, v28
    v_fma_f32 v81, v81, s40, v28
    v_fma_f32 v82, v82, s40, v28
    v_fma_f32 v83, v83, s40, v28
    v_exp_f32 v76, v76
    v_exp_f32 v77, v77
    v_exp_f32 v78, v78
    v_exp_f32 v79, v79
    v_exp_f32 v80, v80
    v_exp_f32 v81, v81
    v_exp_f32 v82, v82
    v_exp_f32 v83, v83
    v_cvt_pk_bf16_f32 v60, v76, v77
    v_cvt_pk_bf16_f32 v61, v78, v79
    v_cvt_pk_bf16_f32 v62, v80, v81
    v_cvt_pk_bf16_f32 v63, v82, v83
    v_mul_f32 v36, v36, v18
    v_mul_f32 v37, v37, v18
    v_mul_f32 v38, v38, v18
    v_mul_f32 v39, v39, v18
    v_mul_f32 v156, v156, v18
    v_mul_f32 v157, v157, v18
    v_mul_f32 v158, v158, v18
    v_mul_f32 v159, v159, v18
    v_mul_f32 v160, v160, v18
    v_mul_f32 v161, v161, v18
    v_mul_f32 v162, v162, v18
    v_mul_f32 v163, v163, v18
    v_mul_f32 v164, v164, v18
    v_mul_f32 v165, v165, v18
    v_mul_f32 v166, v166, v18
    v_mul_f32 v167, v167, v18
    v_mul_f32 v168, v168, v18
    v_mul_f32 v169, v169, v18
    v_mul_f32 v170, v170, v18
    v_mul_f32 v171, v171, v18
    v_mul_f32 v172, v172, v18
    v_mul_f32 v173, v173, v18
    v_mul_f32 v174, v174, v18
    v_mul_f32 v175, v175, v18
    v_mul_f32 v176, v176, v18
    v_mul_f32 v177, v177, v18
    v_mul_f32 v178, v178, v18
    v_mul_f32 v179, v179, v18
    v_mul_f32 v180, v180, v18
    v_mul_f32 v181, v181, v18
    v_mul_f32 v182, v182, v18
    v_mul_f32 v183, v183, v18
    v_mul_f32 v184, v184, v18
    v_mul_f32 v185, v185, v18
    v_mul_f32 v186, v186, v18
    v_mul_f32 v187, v187, v18
    v_fma_f32 v84, v84, s40, v29
    v_fma_f32 v85, v85, s40, v29
    v_fma_f32 v86, v86, s40, v29
    v_fma_f32 v87, v87, s40, v29
    v_fma_f32 v88, v88, s40, v29
    v_fma_f32 v89, v89, s40, v29
    v_fma_f32 v90, v90, s40, v29
    v_fma_f32 v91, v91, s40, v29
    v_exp_f32 v84, v84
    v_exp_f32 v85, v85
    v_exp_f32 v86, v86
    v_exp_f32 v87, v87
    v_exp_f32 v88, v88
    v_exp_f32 v89, v89
    v_exp_f32 v90, v90
    v_exp_f32 v91, v91
    v_cvt_pk_bf16_f32 v64, v84, v85
    v_cvt_pk_bf16_f32 v65, v86, v87
    v_cvt_pk_bf16_f32 v66, v88, v89
    v_cvt_pk_bf16_f32 v67, v90, v91
    v_mul_f32 v40, v40, v19
    v_mul_f32 v41, v41, v19
    v_mul_f32 v42, v42, v19
    v_mul_f32 v43, v43, v19
    v_mul_f32 v188, v188, v19
    v_mul_f32 v189, v189, v19
    v_mul_f32 v190, v190, v19
    v_mul_f32 v191, v191, v19
    v_mul_f32 v192, v192, v19
    v_mul_f32 v193, v193, v19
    v_mul_f32 v194, v194, v19
    v_mul_f32 v195, v195, v19
    v_mul_f32 v196, v196, v19
    v_mul_f32 v197, v197, v19
    v_mul_f32 v198, v198, v19
    v_mul_f32 v199, v199, v19
    v_mul_f32 v200, v200, v19
    v_mul_f32 v201, v201, v19
    v_mul_f32 v202, v202, v19
    v_mul_f32 v203, v203, v19
    v_mul_f32 v204, v204, v19
    v_mul_f32 v205, v205, v19
    v_mul_f32 v206, v206, v19
    v_mul_f32 v207, v207, v19
    v_mul_f32 v208, v208, v19
    v_mul_f32 v209, v209, v19
    v_mul_f32 v210, v210, v19
    v_mul_f32 v211, v211, v19
    v_mul_f32 v212, v212, v19
    v_mul_f32 v213, v213, v19
    v_mul_f32 v214, v214, v19
    v_mul_f32 v215, v215, v19
    v_mul_f32 v216, v216, v19
    v_mul_f32 v217, v217, v19
    v_mul_f32 v218, v218, v19
    v_mul_f32 v219, v219, v19
    s_waitcnt lgkmcnt(14)
    v_mfma_f32_16x16x32_bf16 v[156:159], a[64:67], v[60:63], v[156:159]
    v_mfma_f32_16x16x32_bf16 v[188:191], a[64:67], v[64:67], v[188:191]
    s_waitcnt lgkmcnt(12)
    v_mfma_f32_16x16x32_bf16 v[160:163], a[68:71], v[60:63], v[160:163]
    v_mfma_f32_16x16x32_bf16 v[192:195], a[68:71], v[64:67], v[192:195]
    s_waitcnt lgkmcnt(10)
    v_mfma_f32_16x16x32_bf16 v[164:167], a[72:75], v[60:63], v[164:167]
    v_mfma_f32_16x16x32_bf16 v[196:199], a[72:75], v[64:67], v[196:199]
    s_waitcnt lgkmcnt(8)
    v_mfma_f32_16x16x32_bf16 v[168:171], a[76:79], v[60:63], v[168:171]
    v_mfma_f32_16x16x32_bf16 v[200:203], a[76:79], v[64:67], v[200:203]
    s_waitcnt lgkmcnt(6)
    v_mfma_f32_16x16x32_bf16 v[172:175], a[80:83], v[60:63], v[172:175]
    v_mfma_f32_16x16x32_bf16 v[204:207], a[80:83], v[64:67], v[204:207]
    s_waitcnt lgkmcnt(4)
    v_mfma_f32_16x16x32_bf16 v[176:179], a[84:87], v[60:63], v[176:179]
    v_mfma_f32_16x16x32_bf16 v[208:211], a[84:87], v[64:67], v[208:211]
    s_waitcnt lgkmcnt(2)
    v_mfma_f32_16x16x32_bf16 v[180:183], a[88:91], v[60:63], v[180:183]
    v_mfma_f32_16x16x32_bf16 v[212:215], a[88:91], v[64:67], v[212:215]
    s_waitcnt lgkmcnt(0)
    v_mfma_f32_16x16x32_bf16 v[184:187], a[92:95], v[60:63], v[184:187]
    v_mfma_f32_16x16x32_bf16 v[216:219], a[92:95], v[64:67], v[216:219]
    v_mfma_f32_16x16x32_bf16 v[36:39], v[32:35], v[60:63], v[36:39]
    v_mfma_f32_16x16x32_bf16 v[40:43], v[32:35], v[64:67], v[40:43]
    s_nop 15
    s_add_u32 s42, s42, 8192
    s_cmp_lt_u32 s42, 0x20000
    s_cbranch_scc1 L_fb_loop
    v_rcp_f32 v14, v36
    v_rcp_f32 v15, v40
    s_mov_b32 s43, 4096
    v_mul_f32 v156, v14, v156
    v_mul_f32 v157, v14, v157
    v_mul_f32 v158, v14, v158
    v_mul_f32 v159, v14, v159
    v_mul_f32 v160, v14, v160
    v_mul_f32 v161, v14, v161
    v_mul_f32 v162, v14, v162
    v_mul_f32 v163, v14, v163
    v_cvt_pk_bf16_f32 v156, v156, v157
    v_cvt_pk_bf16_f32 v157, v158, v159
    v_cvt_pk_bf16_f32 v158, v160, v161
    v_cvt_pk_bf16_f32 v159, v162, v163
    ds_write2_b64 v20, v[156:157], v[158:159] offset0:0 offset1:4
    v_mul_f32 v164, v14, v164
    v_mul_f32 v165, v14, v165
    v_mul_f32 v166, v14, v166
    v_mul_f32 v167, v14, v167
    v_mul_f32 v168, v14, v168
    v_mul_f32 v169, v14, v169
    v_mul_f32 v170, v14, v170
    v_mul_f32 v171, v14, v171
    v_cvt_pk_bf16_f32 v164, v164, v165
    v_cvt_pk_bf16_f32 v165, v166, v167
    v_cvt_pk_bf16_f32 v166, v168, v169
    v_cvt_pk_bf16_f32 v167, v170, v171
    ds_write2_b64 v20, v[164:165], v[166:167] offset0:8 offset1:12
    ds_read_b128 v[124:127], v21
    ds_read_b128 v[128:131], v21 offset:1152
    s_waitcnt lgkmcnt(1)
    buffer_store_dwordx4 v[124:127], v22, s[24:27], 0 offen sc1 nt
    s_waitcnt lgkmcnt(0)
    buffer_store_dwordx4 v[128:131], v22, s[24:27], 0 offen offset:2048 sc1 nt
    v_mul_f32 v188, v15, v188
    v_mul_f32 v189, v15, v189
    v_mul_f32 v190, v15, v190
    v_mul_f32 v191, v15, v191
    v_mul_f32 v192, v15, v192
    v_mul_f32 v193, v15, v193
    v_mul_f32 v194, v15, v194
    v_mul_f32 v195, v15, v195
    v_cvt_pk_bf16_f32 v188, v188, v189
    v_cvt_pk_bf16_f32 v189, v190, v191
    v_cvt_pk_bf16_f32 v190, v192, v193
    v_cvt_pk_bf16_f32 v191, v194, v195
    ds_write2_b64 v11, v[188:189], v[190:191] offset0:0 offset1:4
    v_mul_f32 v196, v15, v196
    v_mul_f32 v197, v15, v197
    v_mul_f32 v198, v15, v198
    v_mul_f32 v199, v15, v199
    v_mul_f32 v200, v15, v200
    v_mul_f32 v201, v15, v201
    v_mul_f32 v202, v15, v202
    v_mul_f32 v203, v15, v203
    v_cvt_pk_bf16_f32 v196, v196, v197
    v_cvt_pk_bf16_f32 v197, v198, v199
    v_cvt_pk_bf16_f32 v198, v200, v201
    v_cvt_pk_bf16_f32 v199, v202, v203
    ds_write2_b64 v11, v[196:197], v[198:199] offset0:8 offset1:12
    ds_read_b128 v[132:135], v21 offset:2304
    ds_read_b128 v[136:139], v21 offset:3456
    s_waitcnt lgkmcnt(1)
    buffer_store_dwordx4 v[132:135], v22, s[24:27], s43 offen sc1 nt
    s_waitcnt lgkmcnt(0)
    buffer_store_dwordx4 v[136:139], v22, s[24:27], s43 offen offset:2048 sc1 nt
    v_mul_f32 v172, v14, v172
    v_mul_f32 v173, v14, v173
    v_mul_f32 v174, v14, v174
    v_mul_f32 v175, v14, v175
    v_mul_f32 v176, v14, v176
    v_mul_f32 v177, v14, v177
    v_mul_f32 v178, v14, v178
    v_mul_f32 v179, v14, v179
    v_cvt_pk_bf16_f32 v172, v172, v173
    v_cvt_pk_bf16_f32 v173, v174, v175
    v_cvt_pk_bf16_f32 v174, v176, v177
    v_cvt_pk_bf16_f32 v175, v178, v179
    ds_write2_b64 v30, v[172:173], v[174:175] offset0:0 offset1:4
    v_mul_f32 v180, v14, v180
    v_mul_f32 v181, v14, v181
    v_mul_f32 v182, v14, v182
    v_mul_f32 v183, v14, v183
    v_mul_f32 v184, v14, v184
    v_mul_f32 v185, v14, v185
    v_mul_f32 v186, v14, v186
    v_mul_f32 v187, v14, v187
    v_cvt_pk_bf16_f32 v180, v180, v181
    v_cvt_pk_bf16_f32 v181, v182, v183
    v_cvt_pk_bf16_f32 v182, v184, v185
    v_cvt_pk_bf16_f32 v183, v186, v187
    ds_write2_b64 v30, v[180:181], v[182:183] offset0:8 offset1:12
    ds_read_b128 v[140:143], v21 offset:4608
    ds_read_b128 v[144:147], v21 offset:5760
    s_waitcnt lgkmcnt(1)
    buffer_store_dwordx4 v[140:143], v26, s[24:27], 0 offen sc1 nt
    s_waitcnt lgkmcnt(0)
    buffer_store_dwordx4 v[144:147], v26, s[24:27], 0 offen offset:2048 sc1 nt
    v_mul_f32 v204, v15, v204
    v_mul_f32 v205, v15, v205
    v_mul_f32 v206, v15, v206
    v_mul_f32 v207, v15, v207
    v_mul_f32 v208, v15, v208
    v_mul_f32 v209, v15, v209
    v_mul_f32 v210, v15, v210
    v_mul_f32 v211, v15, v211
    v_cvt_pk_bf16_f32 v204, v204, v205
    v_cvt_pk_bf16_f32 v205, v206, v207
    v_cvt_pk_bf16_f32 v206, v208, v209
    v_cvt_pk_bf16_f32 v207, v210, v211
    ds_write2_b64 v31, v[204:205], v[206:207] offset0:0 offset1:4
    s_waitcnt lgkmcnt(0)
    s_branch L_fin2
.section .rodata,"a"
.p2align 6
.amdhsa_kernel standalone__gqa_softmax__near_ridge_kernel
  .amdhsa_next_free_vgpr 508
  .amdhsa_next_free_sgpr 102
  .amdhsa_accum_offset 252
  .amdhsa_group_segment_fixed_size 0
  .amdhsa_kernarg_size 48
  .amdhsa_user_sgpr_count 2
  .amdhsa_user_sgpr_kernarg_segment_ptr 1
  .amdhsa_system_sgpr_workgroup_id_x 1
.end_amdhsa_kernel
```
